```python
import torch

def _softmax(x, axis=-1):
    return torch.softmax(x, dim=axis)
def _gelu(x):
    return torch.nn.functional.gelu(x, approximate="tanh")
def _silu(x):
    return torch.nn.functional.silu(x)
def _sigmoid(x):
    return torch.sigmoid(x)
def _layernorm(x, axis=-1, eps=1e-5):
    m = x.mean(dim=axis, keepdim=True)
    v = x.var(dim=axis, keepdim=True, unbiased=False)
    return (x - m) / torch.sqrt(v + eps)
def _scatter_add(tgt, idx, src, axis=0):
    return tgt.clone().index_add_(axis, idx, src)
def _segment_sum(src, seg, n):
    out = torch.zeros((n,) + src.shape[1:], dtype=src.dtype)
    return out.index_add_(0, seg, src)
def _pad(x, pw):
    flat = tuple(v for pair in reversed(pw) for v in pair)
    return torch.nn.functional.pad(x, flat)

kernel_name = 'recurrent_scan__mha_block__moe_arch_mod__prompt'

def setup_inputs():

    _w = (lambda a: (lambda t: t.to(torch.bfloat16) if t.is_floating_point() else t)(torch.as_tensor(a)))
    def _A_setup():
        B, S, D, H = 1, 2048, 448, 16
        return {
            "x": _w((lambda *s: torch.randn(*s, dtype=torch.bfloat16) * 0.05)(B, S, D)),
            "wqkv": _w((lambda *s: torch.randn(*s, dtype=torch.bfloat16) * 0.05)(D, 3 * D)),
            "wo": _w((lambda *s: torch.randn(*s, dtype=torch.bfloat16) * 0.05)(D, D)),
        }
    _A_in = _A_setup()

    def _B_setup():
        B, S, D, F, C = 1, 2048, 448, 1792, 1
        return {
            "x": _w((lambda *s: torch.randn(*s, dtype=torch.bfloat16) * 0.05)(B, S, D)),
            "w_r": _w((lambda *s: torch.randn(*s, dtype=torch.bfloat16) * 0.05)(D)),
            "w_gate": _w((lambda *s: torch.randn(*s, dtype=torch.bfloat16) * 0.05)(D, F)),
            "w_up": _w((lambda *s: torch.randn(*s, dtype=torch.bfloat16) * 0.05)(D, F)),
            "w_down": _w((lambda *s: torch.randn(*s, dtype=torch.bfloat16) * 0.05)(F, D)),
        }
    _B_in = _B_setup()

    return {
        "A_x": _A_in["x"],
        "A_wqkv": _A_in["wqkv"],
        "A_wo": _A_in["wo"],
        "B_x": _B_in["x"],
        "B_w_r": _B_in["w_r"],
        "B_w_gate": _B_in["w_gate"],
        "B_w_up": _B_in["w_up"],
        "B_w_down": _B_in["w_down"],
    }

def reference(A_x, A_wqkv, A_wo, B_x, B_w_r, B_w_gate, B_w_up, B_w_down):
    def _A_ref(x, wqkv, wo):
        B, S, D = x.shape
        H = 16
        Dh = D // H
        qkv = (lambda x, *d: x.permute(*d))((x @ wqkv).reshape(B, S, 3, H, Dh), 2, 0, 3, 1, 4)
        q, k, v = qkv[0], qkv[1], qkv[2]
        scores = torch.einsum("bhqd,bhkd->bhqk", q, k) * (Dh ** -0.5)
        p = _softmax(scores, axis=-1)
        o = torch.einsum("bhqk,bhkd->bhqd", p, v)
        return (lambda x, *d: x.permute(*d))(o, 0, 2, 1, 3).reshape(B, S, D) @ wo

    def _B_ref(x, w_r, w_gate, w_up, w_down):
        B, S, D = x.shape
        C = 1
        r = x @ w_r
        idx = torch.argsort(-r, axis=-1)[:, :C]
        idx_e = (lambda x, n, axis: torch.repeat_interleave(x, n, dim=axis))(idx.reshape(B, C, 1), D, axis=2)
        x_sel = (lambda x, i, axis: torch.take_along_dim(x, i, dim=axis))(x, idx_e, axis=1)
        g = _silu(x_sel @ w_gate)
        u = x_sel @ w_up
        y = (g * u) @ w_down
        r_sel = _sigmoid((lambda x, i, axis: torch.take_along_dim(x, i, dim=axis))(r, idx, axis=1))
        y = y * r_sel.reshape(B, C, 1)
        b_off = (torch.arange(B) * S).reshape(B, 1)
        flat_idx = (idx + b_off).reshape(B * C)
        zero = (x * 0.0).reshape(B * S, D)
        upd = _scatter_add(zero, flat_idx, y.reshape(B * C, D), axis=0)
        return x + upd.reshape(B, S, D)

    x = A_x
    xn = _layernorm(x, axis=-1)
    s = _A_ref(xn, A_wqkv, A_wo)
    g = _silu(_B_ref(xn, B_w_r, B_w_gate, B_w_up, B_w_down))
    return x + s * g
```

```asm
; @launch kernel=prep_kernel grid=(126,1,1) block=(256,1,1) lds=3072
; @launch kernel=qkv_kernel grid=(256,1,1) block=(256,1,1) lds=43008
; @launch kernel=attn_kernel grid=(368,1,1) block=(512,1,1) lds=65600
; @launch kernel=out_kernel grid=(256,1,1) block=(256,1,1) lds=512
.amdgcn_target "amdgcn-amd-amdhsa--gfx950"
.text
.globl prep_kernel
.p2align 8
.type prep_kernel,@function
prep_kernel:
    s_load_dwordx16 s[16:31], s[0:1], 0
    s_load_dwordx4 s[32:35], s[0:1], 64
    s_load_dwordx2 s[36:37], s[0:1], 80
    v_and_b32 v1, 63, v0
    v_lshrrev_b32 v2, 6, v0
    v_and_b32 v3, 31, v1
    v_lshrrev_b32 v4, 5, v1
    s_waitcnt lgkmcnt(0)
    s_mov_b32 s40, s16
    s_and_b32 s41, s17, 0xffff
    s_mov_b32 s42, 1835008
    s_mov_b32 s43, 0x00020000
    s_mov_b32 s44, s18
    s_and_b32 s45, s19, 0xffff
    s_mov_b32 s46, 1204224
    s_mov_b32 s47, 0x00020000
    s_mov_b32 s48, s20
    s_and_b32 s49, s21, 0xffff
    s_mov_b32 s50, 401408
    s_mov_b32 s51, 0x00020000
    s_mov_b32 s52, s24
    s_and_b32 s53, s25, 0xffff
    s_mov_b32 s54, 896
    s_mov_b32 s55, 0x00020000
    s_mov_b32 s56, s36
    s_and_b32 s57, s37, 0xffff
    s_mov_b32 s58, 16777216
    s_mov_b32 s59, 0x00020000
    s_cmp_lt_u32 s2, 64
    s_cbranch_scc1 L_prep_ln
    s_cmp_lt_u32 s2, 112
    s_cbranch_scc1 L_prep_wqkv
    s_cmp_lt_u32 s2, 126
    s_cbranch_scc1 L_prep_wo
    s_endpgm
L_prep_ln:
    v_mul_u32_u24 v5, 896, v3
    v_lshlrev_b32 v6, 4, v4
    v_add_u32 v5, v5, v6
    v_lshlrev_b32 v6, 5, v2
    v_add_u32 v5, v5, v6
    v_lshlrev_b32 v7, 4, v4
    v_add_u32 v7, v7, v6
    s_mul_i32 s60, s2, 28672
    buffer_load_dwordx4 v[16:19], v5, s[40:43], s60 offen offset:0
    buffer_load_dwordx4 v[20:23], v5, s[40:43], s60 offen offset:128
    buffer_load_dwordx4 v[24:27], v5, s[40:43], s60 offen offset:256
    buffer_load_dwordx4 v[28:31], v5, s[40:43], s60 offen offset:384
    buffer_load_dwordx4 v[32:35], v5, s[40:43], s60 offen offset:512
    buffer_load_dwordx4 v[36:39], v5, s[40:43], s60 offen offset:640
    buffer_load_dwordx4 v[40:43], v5, s[40:43], s60 offen offset:768
    buffer_load_dwordx4 v[48:51], v7, s[52:55], 0 offen offset:0
    buffer_load_dwordx4 v[52:55], v7, s[52:55], 0 offen offset:128
    buffer_load_dwordx4 v[56:59], v7, s[52:55], 0 offen offset:256
    buffer_load_dwordx4 v[60:63], v7, s[52:55], 0 offen offset:384
    buffer_load_dwordx4 v[64:67], v7, s[52:55], 0 offen offset:512
    buffer_load_dwordx4 v[68:71], v7, s[52:55], 0 offen offset:640
    buffer_load_dwordx4 v[72:75], v7, s[52:55], 0 offen offset:768
    v_mov_b32 v76, 0x3f803f80
    v_mov_b32 v77, 0
    v_mov_b32 v78, 0
    v_lshlrev_b32 v8, 5, v3
    v_lshlrev_b32 v9, 1, v2
    v_add_u32 v9, v9, v4
    v_lshlrev_b32 v9, 2, v9
    v_add_u32 v9, v9, v8
    s_waitcnt vmcnt(7)
    v_dot2_f32_bf16 v77, v16, v76, v77
    v_dot2_f32_bf16 v78, v17, v76, v78
    v_dot2_f32_bf16 v77, v18, v76, v77
    v_dot2_f32_bf16 v78, v19, v76, v78
    v_dot2_f32_bf16 v77, v20, v76, v77
    v_dot2_f32_bf16 v78, v21, v76, v78
    v_dot2_f32_bf16 v77, v22, v76, v77
    v_dot2_f32_bf16 v78, v23, v76, v78
    v_dot2_f32_bf16 v77, v24, v76, v77
    v_dot2_f32_bf16 v78, v25, v76, v78
    v_dot2_f32_bf16 v77, v26, v76, v77
    v_dot2_f32_bf16 v78, v27, v76, v78
    v_dot2_f32_bf16 v77, v28, v76, v77
    v_dot2_f32_bf16 v78, v29, v76, v78
    v_dot2_f32_bf16 v77, v30, v76, v77
    v_dot2_f32_bf16 v78, v31, v76, v78
    v_dot2_f32_bf16 v77, v32, v76, v77
    v_dot2_f32_bf16 v78, v33, v76, v78
    v_dot2_f32_bf16 v77, v34, v76, v77
    v_dot2_f32_bf16 v78, v35, v76, v78
    v_dot2_f32_bf16 v77, v36, v76, v77
    v_dot2_f32_bf16 v78, v37, v76, v78
    v_dot2_f32_bf16 v77, v38, v76, v77
    v_dot2_f32_bf16 v78, v39, v76, v78
    v_dot2_f32_bf16 v77, v40, v76, v77
    v_dot2_f32_bf16 v78, v41, v76, v78
    v_dot2_f32_bf16 v77, v42, v76, v77
    v_dot2_f32_bf16 v78, v43, v76, v78
    s_nop 2
    v_add_f32 v77, v77, v78
    ds_write_b32 v9, v77
    s_waitcnt lgkmcnt(0)
    s_barrier
    ds_read_b128 v[80:83], v8
    ds_read_b128 v[84:87], v8 offset:16
    s_waitcnt lgkmcnt(0)
    v_add_f32 v80, v80, v81
    v_add_f32 v82, v82, v83
    v_add_f32 v84, v84, v85
    v_add_f32 v86, v86, v87
    v_add_f32 v80, v80, v82
    v_add_f32 v84, v84, v86
    v_add_f32 v80, v80, v84
    v_mul_f32 v79, 0x3b124925, v80
    v_mov_b32 v77, 0
    v_mov_b32 v78, 0
    v_lshlrev_b32 v80, 16, v16
    v_and_b32 v81, 0xffff0000, v16
    v_sub_f32 v80, v80, v79
    v_sub_f32 v81, v81, v79
    v_fma_f32 v77, v80, v80, v77
    v_fma_f32 v78, v81, v81, v78
    v_lshlrev_b32 v80, 16, v17
    v_and_b32 v81, 0xffff0000, v17
    v_sub_f32 v80, v80, v79
    v_sub_f32 v81, v81, v79
    v_fma_f32 v77, v80, v80, v77
    v_fma_f32 v78, v81, v81, v78
    v_lshlrev_b32 v80, 16, v18
    v_and_b32 v81, 0xffff0000, v18
    v_sub_f32 v80, v80, v79
    v_sub_f32 v81, v81, v79
    v_fma_f32 v77, v80, v80, v77
    v_fma_f32 v78, v81, v81, v78
    v_lshlrev_b32 v80, 16, v19
    v_and_b32 v81, 0xffff0000, v19
    v_sub_f32 v80, v80, v79
    v_sub_f32 v81, v81, v79
    v_fma_f32 v77, v80, v80, v77
    v_fma_f32 v78, v81, v81, v78
    v_lshlrev_b32 v80, 16, v20
    v_and_b32 v81, 0xffff0000, v20
    v_sub_f32 v80, v80, v79
    v_sub_f32 v81, v81, v79
    v_fma_f32 v77, v80, v80, v77
    v_fma_f32 v78, v81, v81, v78
    v_lshlrev_b32 v80, 16, v21
    v_and_b32 v81, 0xffff0000, v21
    v_sub_f32 v80, v80, v79
    v_sub_f32 v81, v81, v79
    v_fma_f32 v77, v80, v80, v77
    v_fma_f32 v78, v81, v81, v78
    v_lshlrev_b32 v80, 16, v22
    v_and_b32 v81, 0xffff0000, v22
    v_sub_f32 v80, v80, v79
    v_sub_f32 v81, v81, v79
    v_fma_f32 v77, v80, v80, v77
    v_fma_f32 v78, v81, v81, v78
    v_lshlrev_b32 v80, 16, v23
    v_and_b32 v81, 0xffff0000, v23
    v_sub_f32 v80, v80, v79
    v_sub_f32 v81, v81, v79
    v_fma_f32 v77, v80, v80, v77
    v_fma_f32 v78, v81, v81, v78
    v_lshlrev_b32 v80, 16, v24
    v_and_b32 v81, 0xffff0000, v24
    v_sub_f32 v80, v80, v79
    v_sub_f32 v81, v81, v79
    v_fma_f32 v77, v80, v80, v77
    v_fma_f32 v78, v81, v81, v78
    v_lshlrev_b32 v80, 16, v25
    v_and_b32 v81, 0xffff0000, v25
    v_sub_f32 v80, v80, v79
    v_sub_f32 v81, v81, v79
    v_fma_f32 v77, v80, v80, v77
    v_fma_f32 v78, v81, v81, v78
    v_lshlrev_b32 v80, 16, v26
    v_and_b32 v81, 0xffff0000, v26
    v_sub_f32 v80, v80, v79
    v_sub_f32 v81, v81, v79
    v_fma_f32 v77, v80, v80, v77
    v_fma_f32 v78, v81, v81, v78
    v_lshlrev_b32 v80, 16, v27
    v_and_b32 v81, 0xffff0000, v27
    v_sub_f32 v80, v80, v79
    v_sub_f32 v81, v81, v79
    v_fma_f32 v77, v80, v80, v77
    v_fma_f32 v78, v81, v81, v78
    v_lshlrev_b32 v80, 16, v28
    v_and_b32 v81, 0xffff0000, v28
    v_sub_f32 v80, v80, v79
    v_sub_f32 v81, v81, v79
    v_fma_f32 v77, v80, v80, v77
    v_fma_f32 v78, v81, v81, v78
    v_lshlrev_b32 v80, 16, v29
    v_and_b32 v81, 0xffff0000, v29
    v_sub_f32 v80, v80, v79
    v_sub_f32 v81, v81, v79
    v_fma_f32 v77, v80, v80, v77
    v_fma_f32 v78, v81, v81, v78
    v_lshlrev_b32 v80, 16, v30
    v_and_b32 v81, 0xffff0000, v30
    v_sub_f32 v80, v80, v79
    v_sub_f32 v81, v81, v79
    v_fma_f32 v77, v80, v80, v77
    v_fma_f32 v78, v81, v81, v78
    v_lshlrev_b32 v80, 16, v31
    v_and_b32 v81, 0xffff0000, v31
    v_sub_f32 v80, v80, v79
    v_sub_f32 v81, v81, v79
    v_fma_f32 v77, v80, v80, v77
    v_fma_f32 v78, v81, v81, v78
    v_lshlrev_b32 v80, 16, v32
    v_and_b32 v81, 0xffff0000, v32
    v_sub_f32 v80, v80, v79
    v_sub_f32 v81, v81, v79
    v_fma_f32 v77, v80, v80, v77
    v_fma_f32 v78, v81, v81, v78
    v_lshlrev_b32 v80, 16, v33
    v_and_b32 v81, 0xffff0000, v33
    v_sub_f32 v80, v80, v79
    v_sub_f32 v81, v81, v79
    v_fma_f32 v77, v80, v80, v77
    v_fma_f32 v78, v81, v81, v78
    v_lshlrev_b32 v80, 16, v34
    v_and_b32 v81, 0xffff0000, v34
    v_sub_f32 v80, v80, v79
    v_sub_f32 v81, v81, v79
    v_fma_f32 v77, v80, v80, v77
    v_fma_f32 v78, v81, v81, v78
    v_lshlrev_b32 v80, 16, v35
    v_and_b32 v81, 0xffff0000, v35
    v_sub_f32 v80, v80, v79
    v_sub_f32 v81, v81, v79
    v_fma_f32 v77, v80, v80, v77
    v_fma_f32 v78, v81, v81, v78
    v_lshlrev_b32 v80, 16, v36
    v_and_b32 v81, 0xffff0000, v36
    v_sub_f32 v80, v80, v79
    v_sub_f32 v81, v81, v79
    v_fma_f32 v77, v80, v80, v77
    v_fma_f32 v78, v81, v81, v78
    v_lshlrev_b32 v80, 16, v37
    v_and_b32 v81, 0xffff0000, v37
    v_sub_f32 v80, v80, v79
    v_sub_f32 v81, v81, v79
    v_fma_f32 v77, v80, v80, v77
    v_fma_f32 v78, v81, v81, v78
    v_lshlrev_b32 v80, 16, v38
    v_and_b32 v81, 0xffff0000, v38
    v_sub_f32 v80, v80, v79
    v_sub_f32 v81, v81, v79
    v_fma_f32 v77, v80, v80, v77
    v_fma_f32 v78, v81, v81, v78
    v_lshlrev_b32 v80, 16, v39
    v_and_b32 v81, 0xffff0000, v39
    v_sub_f32 v80, v80, v79
    v_sub_f32 v81, v81, v79
    v_fma_f32 v77, v80, v80, v77
    v_fma_f32 v78, v81, v81, v78
    v_lshlrev_b32 v80, 16, v40
    v_and_b32 v81, 0xffff0000, v40
    v_sub_f32 v80, v80, v79
    v_sub_f32 v81, v81, v79
    v_fma_f32 v77, v80, v80, v77
    v_fma_f32 v78, v81, v81, v78
    v_lshlrev_b32 v80, 16, v41
    v_and_b32 v81, 0xffff0000, v41
    v_sub_f32 v80, v80, v79
    v_sub_f32 v81, v81, v79
    v_fma_f32 v77, v80, v80, v77
    v_fma_f32 v78, v81, v81, v78
    v_lshlrev_b32 v80, 16, v42
    v_and_b32 v81, 0xffff0000, v42
    v_sub_f32 v80, v80, v79
    v_sub_f32 v81, v81, v79
    v_fma_f32 v77, v80, v80, v77
    v_fma_f32 v78, v81, v81, v78
    v_lshlrev_b32 v80, 16, v43
    v_and_b32 v81, 0xffff0000, v43
    v_sub_f32 v80, v80, v79
    v_sub_f32 v81, v81, v79
    v_fma_f32 v77, v80, v80, v77
    v_fma_f32 v78, v81, v81, v78
    v_add_f32 v77, v77, v78
    ds_write_b32 v9, v77 offset:1024
    s_waitcnt lgkmcnt(0)
    s_barrier
    ds_read_b128 v[80:83], v8 offset:1024
    ds_read_b128 v[84:87], v8 offset:1040
    s_waitcnt lgkmcnt(0)
    v_add_f32 v80, v80, v81
    v_add_f32 v82, v82, v83
    v_add_f32 v84, v84, v85
    v_add_f32 v86, v86, v87
    v_add_f32 v80, v80, v82
    v_add_f32 v84, v84, v86
    v_add_f32 v80, v80, v84
    v_mul_f32 v80, 0x3b124925, v80
    v_cvt_pk_bf16_f32 v81, v80, v79
    v_and_b32 v88, 0xffff0000, v81
    v_lshlrev_b32 v82, 16, v81
    v_add_f32 v82, 0x3727c5ac, v82
    v_cvt_pk_bf16_f32 v83, v82, v82
    v_lshlrev_b32 v83, 16, v83
    v_sqrt_f32 v84, v83
    s_nop 0
    v_cvt_pk_bf16_f32 v85, v84, v84
    v_lshlrev_b32 v89, 16, v85
    v_rcp_f32 v90, v89
    v_lshlrev_b32 v80, 16, v16
    v_and_b32 v81, 0xffff0000, v16
    v_sub_f32 v80, v80, v88
    v_sub_f32 v81, v81, v88
    v_cvt_pk_bf16_f32 v82, v80, v81
    v_lshlrev_b32 v80, 16, v82
    v_and_b32 v81, 0xffff0000, v82
    v_mul_f32 v80, v80, v90
    v_mul_f32 v81, v81, v90
    v_cvt_pk_bf16_f32 v16, v80, v81
    v_lshlrev_b32 v80, 16, v17
    v_and_b32 v81, 0xffff0000, v17
    v_sub_f32 v80, v80, v88
    v_sub_f32 v81, v81, v88
    v_cvt_pk_bf16_f32 v82, v80, v81
    v_lshlrev_b32 v80, 16, v82
    v_and_b32 v81, 0xffff0000, v82
    v_mul_f32 v80, v80, v90
    v_mul_f32 v81, v81, v90
    v_cvt_pk_bf16_f32 v17, v80, v81
    v_lshlrev_b32 v80, 16, v18
    v_and_b32 v81, 0xffff0000, v18
    v_sub_f32 v80, v80, v88
    v_sub_f32 v81, v81, v88
    v_cvt_pk_bf16_f32 v82, v80, v81
    v_lshlrev_b32 v80, 16, v82
    v_and_b32 v81, 0xffff0000, v82
    v_mul_f32 v80, v80, v90
    v_mul_f32 v81, v81, v90
    v_cvt_pk_bf16_f32 v18, v80, v81
    v_lshlrev_b32 v80, 16, v19
    v_and_b32 v81, 0xffff0000, v19
    v_sub_f32 v80, v80, v88
    v_sub_f32 v81, v81, v88
    v_cvt_pk_bf16_f32 v82, v80, v81
    v_lshlrev_b32 v80, 16, v82
    v_and_b32 v81, 0xffff0000, v82
    v_mul_f32 v80, v80, v90
    v_mul_f32 v81, v81, v90
    v_cvt_pk_bf16_f32 v19, v80, v81
    v_lshlrev_b32 v80, 16, v20
    v_and_b32 v81, 0xffff0000, v20
    v_sub_f32 v80, v80, v88
    v_sub_f32 v81, v81, v88
    v_cvt_pk_bf16_f32 v82, v80, v81
    v_lshlrev_b32 v80, 16, v82
    v_and_b32 v81, 0xffff0000, v82
    v_mul_f32 v80, v80, v90
    v_mul_f32 v81, v81, v90
    v_cvt_pk_bf16_f32 v20, v80, v81
    v_lshlrev_b32 v80, 16, v21
    v_and_b32 v81, 0xffff0000, v21
    v_sub_f32 v80, v80, v88
    v_sub_f32 v81, v81, v88
    v_cvt_pk_bf16_f32 v82, v80, v81
    v_lshlrev_b32 v80, 16, v82
    v_and_b32 v81, 0xffff0000, v82
    v_mul_f32 v80, v80, v90
    v_mul_f32 v81, v81, v90
    v_cvt_pk_bf16_f32 v21, v80, v81
    v_lshlrev_b32 v80, 16, v22
    v_and_b32 v81, 0xffff0000, v22
    v_sub_f32 v80, v80, v88
    v_sub_f32 v81, v81, v88
    v_cvt_pk_bf16_f32 v82, v80, v81
    v_lshlrev_b32 v80, 16, v82
    v_and_b32 v81, 0xffff0000, v82
    v_mul_f32 v80, v80, v90
    v_mul_f32 v81, v81, v90
    v_cvt_pk_bf16_f32 v22, v80, v81
    v_lshlrev_b32 v80, 16, v23
    v_and_b32 v81, 0xffff0000, v23
    v_sub_f32 v80, v80, v88
    v_sub_f32 v81, v81, v88
    v_cvt_pk_bf16_f32 v82, v80, v81
    v_lshlrev_b32 v80, 16, v82
    v_and_b32 v81, 0xffff0000, v82
    v_mul_f32 v80, v80, v90
    v_mul_f32 v81, v81, v90
    v_cvt_pk_bf16_f32 v23, v80, v81
    v_lshlrev_b32 v80, 16, v24
    v_and_b32 v81, 0xffff0000, v24
    v_sub_f32 v80, v80, v88
    v_sub_f32 v81, v81, v88
    v_cvt_pk_bf16_f32 v82, v80, v81
    v_lshlrev_b32 v80, 16, v82
    v_and_b32 v81, 0xffff0000, v82
    v_mul_f32 v80, v80, v90
    v_mul_f32 v81, v81, v90
    v_cvt_pk_bf16_f32 v24, v80, v81
    v_lshlrev_b32 v80, 16, v25
    v_and_b32 v81, 0xffff0000, v25
    v_sub_f32 v80, v80, v88
    v_sub_f32 v81, v81, v88
    v_cvt_pk_bf16_f32 v82, v80, v81
    v_lshlrev_b32 v80, 16, v82
    v_and_b32 v81, 0xffff0000, v82
    v_mul_f32 v80, v80, v90
    v_mul_f32 v81, v81, v90
    v_cvt_pk_bf16_f32 v25, v80, v81
    v_lshlrev_b32 v80, 16, v26
    v_and_b32 v81, 0xffff0000, v26
    v_sub_f32 v80, v80, v88
    v_sub_f32 v81, v81, v88
    v_cvt_pk_bf16_f32 v82, v80, v81
    v_lshlrev_b32 v80, 16, v82
    v_and_b32 v81, 0xffff0000, v82
    v_mul_f32 v80, v80, v90
    v_mul_f32 v81, v81, v90
    v_cvt_pk_bf16_f32 v26, v80, v81
    v_lshlrev_b32 v80, 16, v27
    v_and_b32 v81, 0xffff0000, v27
    v_sub_f32 v80, v80, v88
    v_sub_f32 v81, v81, v88
    v_cvt_pk_bf16_f32 v82, v80, v81
    v_lshlrev_b32 v80, 16, v82
    v_and_b32 v81, 0xffff0000, v82
    v_mul_f32 v80, v80, v90
    v_mul_f32 v81, v81, v90
    v_cvt_pk_bf16_f32 v27, v80, v81
    v_lshlrev_b32 v80, 16, v28
    v_and_b32 v81, 0xffff0000, v28
    v_sub_f32 v80, v80, v88
    v_sub_f32 v81, v81, v88
    v_cvt_pk_bf16_f32 v82, v80, v81
    v_lshlrev_b32 v80, 16, v82
    v_and_b32 v81, 0xffff0000, v82
    v_mul_f32 v80, v80, v90
    v_mul_f32 v81, v81, v90
    v_cvt_pk_bf16_f32 v28, v80, v81
    v_lshlrev_b32 v80, 16, v29
    v_and_b32 v81, 0xffff0000, v29
    v_sub_f32 v80, v80, v88
    v_sub_f32 v81, v81, v88
    v_cvt_pk_bf16_f32 v82, v80, v81
    v_lshlrev_b32 v80, 16, v82
    v_and_b32 v81, 0xffff0000, v82
    v_mul_f32 v80, v80, v90
    v_mul_f32 v81, v81, v90
    v_cvt_pk_bf16_f32 v29, v80, v81
    v_lshlrev_b32 v80, 16, v30
    v_and_b32 v81, 0xffff0000, v30
    v_sub_f32 v80, v80, v88
    v_sub_f32 v81, v81, v88
    v_cvt_pk_bf16_f32 v82, v80, v81
    v_lshlrev_b32 v80, 16, v82
    v_and_b32 v81, 0xffff0000, v82
    v_mul_f32 v80, v80, v90
    v_mul_f32 v81, v81, v90
    v_cvt_pk_bf16_f32 v30, v80, v81
    v_lshlrev_b32 v80, 16, v31
    v_and_b32 v81, 0xffff0000, v31
    v_sub_f32 v80, v80, v88
    v_sub_f32 v81, v81, v88
    v_cvt_pk_bf16_f32 v82, v80, v81
    v_lshlrev_b32 v80, 16, v82
    v_and_b32 v81, 0xffff0000, v82
    v_mul_f32 v80, v80, v90
    v_mul_f32 v81, v81, v90
    v_cvt_pk_bf16_f32 v31, v80, v81
    v_lshlrev_b32 v80, 16, v32
    v_and_b32 v81, 0xffff0000, v32
    v_sub_f32 v80, v80, v88
    v_sub_f32 v81, v81, v88
    v_cvt_pk_bf16_f32 v82, v80, v81
    v_lshlrev_b32 v80, 16, v82
    v_and_b32 v81, 0xffff0000, v82
    v_mul_f32 v80, v80, v90
    v_mul_f32 v81, v81, v90
    v_cvt_pk_bf16_f32 v32, v80, v81
    v_lshlrev_b32 v80, 16, v33
    v_and_b32 v81, 0xffff0000, v33
    v_sub_f32 v80, v80, v88
    v_sub_f32 v81, v81, v88
    v_cvt_pk_bf16_f32 v82, v80, v81
    v_lshlrev_b32 v80, 16, v82
    v_and_b32 v81, 0xffff0000, v82
    v_mul_f32 v80, v80, v90
    v_mul_f32 v81, v81, v90
    v_cvt_pk_bf16_f32 v33, v80, v81
    v_lshlrev_b32 v80, 16, v34
    v_and_b32 v81, 0xffff0000, v34
    v_sub_f32 v80, v80, v88
    v_sub_f32 v81, v81, v88
    v_cvt_pk_bf16_f32 v82, v80, v81
    v_lshlrev_b32 v80, 16, v82
    v_and_b32 v81, 0xffff0000, v82
    v_mul_f32 v80, v80, v90
    v_mul_f32 v81, v81, v90
    v_cvt_pk_bf16_f32 v34, v80, v81
    v_lshlrev_b32 v80, 16, v35
    v_and_b32 v81, 0xffff0000, v35
    v_sub_f32 v80, v80, v88
    v_sub_f32 v81, v81, v88
    v_cvt_pk_bf16_f32 v82, v80, v81
    v_lshlrev_b32 v80, 16, v82
    v_and_b32 v81, 0xffff0000, v82
    v_mul_f32 v80, v80, v90
    v_mul_f32 v81, v81, v90
    v_cvt_pk_bf16_f32 v35, v80, v81
    v_lshlrev_b32 v80, 16, v36
    v_and_b32 v81, 0xffff0000, v36
    v_sub_f32 v80, v80, v88
    v_sub_f32 v81, v81, v88
    v_cvt_pk_bf16_f32 v82, v80, v81
    v_lshlrev_b32 v80, 16, v82
    v_and_b32 v81, 0xffff0000, v82
    v_mul_f32 v80, v80, v90
    v_mul_f32 v81, v81, v90
    v_cvt_pk_bf16_f32 v36, v80, v81
    v_lshlrev_b32 v80, 16, v37
    v_and_b32 v81, 0xffff0000, v37
    v_sub_f32 v80, v80, v88
    v_sub_f32 v81, v81, v88
    v_cvt_pk_bf16_f32 v82, v80, v81
    v_lshlrev_b32 v80, 16, v82
    v_and_b32 v81, 0xffff0000, v82
    v_mul_f32 v80, v80, v90
    v_mul_f32 v81, v81, v90
    v_cvt_pk_bf16_f32 v37, v80, v81
    v_lshlrev_b32 v80, 16, v38
    v_and_b32 v81, 0xffff0000, v38
    v_sub_f32 v80, v80, v88
    v_sub_f32 v81, v81, v88
    v_cvt_pk_bf16_f32 v82, v80, v81
    v_lshlrev_b32 v80, 16, v82
    v_and_b32 v81, 0xffff0000, v82
    v_mul_f32 v80, v80, v90
    v_mul_f32 v81, v81, v90
    v_cvt_pk_bf16_f32 v38, v80, v81
    v_lshlrev_b32 v80, 16, v39
    v_and_b32 v81, 0xffff0000, v39
    v_sub_f32 v80, v80, v88
    v_sub_f32 v81, v81, v88
    v_cvt_pk_bf16_f32 v82, v80, v81
    v_lshlrev_b32 v80, 16, v82
    v_and_b32 v81, 0xffff0000, v82
    v_mul_f32 v80, v80, v90
    v_mul_f32 v81, v81, v90
    v_cvt_pk_bf16_f32 v39, v80, v81
    v_lshlrev_b32 v80, 16, v40
    v_and_b32 v81, 0xffff0000, v40
    v_sub_f32 v80, v80, v88
    v_sub_f32 v81, v81, v88
    v_cvt_pk_bf16_f32 v82, v80, v81
    v_lshlrev_b32 v80, 16, v82
    v_and_b32 v81, 0xffff0000, v82
    v_mul_f32 v80, v80, v90
    v_mul_f32 v81, v81, v90
    v_cvt_pk_bf16_f32 v40, v80, v81
    v_lshlrev_b32 v80, 16, v41
    v_and_b32 v81, 0xffff0000, v41
    v_sub_f32 v80, v80, v88
    v_sub_f32 v81, v81, v88
    v_cvt_pk_bf16_f32 v82, v80, v81
    v_lshlrev_b32 v80, 16, v82
    v_and_b32 v81, 0xffff0000, v82
    v_mul_f32 v80, v80, v90
    v_mul_f32 v81, v81, v90
    v_cvt_pk_bf16_f32 v41, v80, v81
    v_lshlrev_b32 v80, 16, v42
    v_and_b32 v81, 0xffff0000, v42
    v_sub_f32 v80, v80, v88
    v_sub_f32 v81, v81, v88
    v_cvt_pk_bf16_f32 v82, v80, v81
    v_lshlrev_b32 v80, 16, v82
    v_and_b32 v81, 0xffff0000, v82
    v_mul_f32 v80, v80, v90
    v_mul_f32 v81, v81, v90
    v_cvt_pk_bf16_f32 v42, v80, v81
    v_lshlrev_b32 v80, 16, v43
    v_and_b32 v81, 0xffff0000, v43
    v_sub_f32 v80, v80, v88
    v_sub_f32 v81, v81, v88
    v_cvt_pk_bf16_f32 v82, v80, v81
    v_lshlrev_b32 v80, 16, v82
    v_and_b32 v81, 0xffff0000, v82
    v_mul_f32 v80, v80, v90
    v_mul_f32 v81, v81, v90
    v_cvt_pk_bf16_f32 v43, v80, v81
    v_mov_b32 v77, 0
    v_mov_b32 v78, 0
    s_waitcnt vmcnt(0)
    v_dot2_f32_bf16 v77, v16, v48, v77
    v_dot2_f32_bf16 v78, v17, v49, v78
    v_dot2_f32_bf16 v77, v18, v50, v77
    v_dot2_f32_bf16 v78, v19, v51, v78
    v_dot2_f32_bf16 v77, v20, v52, v77
    v_dot2_f32_bf16 v78, v21, v53, v78
    v_dot2_f32_bf16 v77, v22, v54, v77
    v_dot2_f32_bf16 v78, v23, v55, v78
    v_dot2_f32_bf16 v77, v24, v56, v77
    v_dot2_f32_bf16 v78, v25, v57, v78
    v_dot2_f32_bf16 v77, v26, v58, v77
    v_dot2_f32_bf16 v78, v27, v59, v78
    v_dot2_f32_bf16 v77, v28, v60, v77
    v_dot2_f32_bf16 v78, v29, v61, v78
    v_dot2_f32_bf16 v77, v30, v62, v77
    v_dot2_f32_bf16 v78, v31, v63, v78
    v_dot2_f32_bf16 v77, v32, v64, v77
    v_dot2_f32_bf16 v78, v33, v65, v78
    v_dot2_f32_bf16 v77, v34, v66, v77
    v_dot2_f32_bf16 v78, v35, v67, v78
    v_dot2_f32_bf16 v77, v36, v68, v77
    v_dot2_f32_bf16 v78, v37, v69, v78
    v_dot2_f32_bf16 v77, v38, v70, v77
    v_dot2_f32_bf16 v78, v39, v71, v78
    v_dot2_f32_bf16 v77, v40, v72, v77
    v_dot2_f32_bf16 v78, v41, v73, v78
    v_dot2_f32_bf16 v77, v42, v74, v77
    v_dot2_f32_bf16 v78, v43, v75, v78
    s_nop 2
    v_add_f32 v77, v77, v78
    ds_write_b32 v9, v77 offset:2048
    v_lshlrev_b32 v10, 4, v1
    v_lshlrev_b32 v11, 10, v2
    v_add_u32 v10, v10, v11
    s_mul_i32 s61, s2, 28672
    s_add_u32 s61, s61, 0
    s_add_u32 s62, s61, 0
    buffer_store_dwordx4 v[16:19], v10, s[56:59], s62 offen
    s_add_u32 s62, s61, 4096
    buffer_store_dwordx4 v[20:23], v10, s[56:59], s62 offen
    s_add_u32 s62, s61, 8192
    buffer_store_dwordx4 v[24:27], v10, s[56:59], s62 offen
    s_add_u32 s62, s61, 12288
    buffer_store_dwordx4 v[28:31], v10, s[56:59], s62 offen
    s_add_u32 s62, s61, 16384
    buffer_store_dwordx4 v[32:35], v10, s[56:59], s62 offen
    s_add_u32 s62, s61, 20480
    buffer_store_dwordx4 v[36:39], v10, s[56:59], s62 offen
    s_add_u32 s62, s61, 24576
    buffer_store_dwordx4 v[40:43], v10, s[56:59], s62 offen
    s_waitcnt lgkmcnt(0)
    s_barrier
    v_cmp_gt_u32 vcc, 32, v0
    s_nop 3
    s_and_saveexec_b64 s[64:65], vcc
    ds_read_b128 v[80:83], v8 offset:2048
    ds_read_b128 v[84:87], v8 offset:2064
    s_waitcnt lgkmcnt(0)
    v_add_f32 v80, v80, v81
    v_add_f32 v82, v82, v83
    v_add_f32 v84, v84, v85
    v_add_f32 v86, v86, v87
    v_add_f32 v80, v80, v82
    v_add_f32 v84, v84, v86
    v_add_f32 v80, v80, v84
    v_lshlrev_b32 v12, 2, v3
    s_lshl_b32 s62, s2, 7
    s_add_u32 s62, s62, 4227072
    buffer_store_dword v80, v12, s[56:59], s62 offen
    v_lshlrev_b32 v12, 3, v3
    s_lshl_b32 s63, s2, 8
    s_add_u32 s63, s63, 4194304
    buffer_store_dwordx2 v[88:89], v12, s[56:59], s63 offen
    s_mov_b64 exec, s[64:65]
    s_waitcnt vmcnt(0)
    s_endpgm
L_prep_wqkv:
    s_sub_u32 s60, s2, 64
    s_lshr_b32 s61, s60, 4
    s_and_b32 s62, s60, 15
    s_mul_i32 s61, s61, 896
    s_mul_i32 s62, s62, 56
    s_add_u32 s61, s61, s62
    v_mul_u32_u24 v5, 21504, v4
    v_lshlrev_b32 v6, 1, v3
    v_add_u32 v5, v5, v6
    v_mul_u32_u24 v6, 301056, v2
    v_add_u32 v5, v5, v6
    s_mov_b32 s66, 0x0fffffff
    s_mov_b32 s67, 0x0fffffff
    v_mov_b32 v16, 0
    v_mov_b32 v17, 0
    v_mov_b32 v18, 0
    v_mov_b32 v19, 0
    v_mov_b32 v20, 0
    v_mov_b32 v21, 0
    v_mov_b32 v22, 0
    v_mov_b32 v23, 0
    v_mov_b32 v24, 0
    v_mov_b32 v25, 0
    v_mov_b32 v26, 0
    v_mov_b32 v27, 0
    v_mov_b32 v28, 0
    v_mov_b32 v29, 0
    v_mov_b32 v30, 0
    v_mov_b32 v31, 0
    v_mov_b32 v32, 0
    v_mov_b32 v33, 0
    v_mov_b32 v34, 0
    v_mov_b32 v35, 0
    v_mov_b32 v36, 0
    v_mov_b32 v37, 0
    v_mov_b32 v38, 0
    v_mov_b32 v39, 0
    v_mov_b32 v40, 0
    v_mov_b32 v41, 0
    v_mov_b32 v42, 0
    v_mov_b32 v43, 0
    v_mov_b32 v44, 0
    v_mov_b32 v45, 0
    v_mov_b32 v46, 0
    v_mov_b32 v47, 0
    v_mov_b32 v48, 0
    v_mov_b32 v49, 0
    v_mov_b32 v50, 0
    v_mov_b32 v51, 0
    v_mov_b32 v52, 0
    v_mov_b32 v53, 0
    v_mov_b32 v54, 0
    v_mov_b32 v55, 0
    v_mov_b32 v56, 0
    v_mov_b32 v57, 0
    v_mov_b32 v58, 0
    v_mov_b32 v59, 0
    v_mov_b32 v60, 0
    v_mov_b32 v61, 0
    v_mov_b32 v62, 0
    v_mov_b32 v63, 0
    v_mov_b32 v64, 0
    v_mov_b32 v65, 0
    v_mov_b32 v66, 0
    v_mov_b32 v67, 0
    v_mov_b32 v68, 0
    v_mov_b32 v69, 0
    v_mov_b32 v70, 0
    v_mov_b32 v71, 0
    s_mov_b64 exec, s[66:67]
    s_add_u32 s63, s61, 0
    buffer_load_ushort v16, v5, s[44:47], s63 offen
    s_add_u32 s63, s61, 2688
    buffer_load_ushort v44, v5, s[44:47], s63 offen
    s_add_u32 s63, s61, 5376
    buffer_load_ushort v17, v5, s[44:47], s63 offen
    s_add_u32 s63, s61, 8064
    buffer_load_ushort v45, v5, s[44:47], s63 offen
    s_add_u32 s63, s61, 10752
    buffer_load_ushort v18, v5, s[44:47], s63 offen
    s_add_u32 s63, s61, 13440
    buffer_load_ushort v46, v5, s[44:47], s63 offen
    s_add_u32 s63, s61, 16128
    buffer_load_ushort v19, v5, s[44:47], s63 offen
    s_add_u32 s63, s61, 18816
    buffer_load_ushort v47, v5, s[44:47], s63 offen
    s_add_u32 s63, s61, 43008
    buffer_load_ushort v20, v5, s[44:47], s63 offen
    s_add_u32 s63, s61, 45696
    buffer_load_ushort v48, v5, s[44:47], s63 offen
    s_add_u32 s63, s61, 48384
    buffer_load_ushort v21, v5, s[44:47], s63 offen
    s_add_u32 s63, s61, 51072
    buffer_load_ushort v49, v5, s[44:47], s63 offen
    s_add_u32 s63, s61, 53760
    buffer_load_ushort v22, v5, s[44:47], s63 offen
    s_add_u32 s63, s61, 56448
    buffer_load_ushort v50, v5, s[44:47], s63 offen
    s_add_u32 s63, s61, 59136
    buffer_load_ushort v23, v5, s[44:47], s63 offen
    s_add_u32 s63, s61, 61824
    buffer_load_ushort v51, v5, s[44:47], s63 offen
    s_add_u32 s63, s61, 86016
    buffer_load_ushort v24, v5, s[44:47], s63 offen
    s_add_u32 s63, s61, 88704
    buffer_load_ushort v52, v5, s[44:47], s63 offen
    s_add_u32 s63, s61, 91392
    buffer_load_ushort v25, v5, s[44:47], s63 offen
    s_add_u32 s63, s61, 94080
    buffer_load_ushort v53, v5, s[44:47], s63 offen
    s_add_u32 s63, s61, 96768
    buffer_load_ushort v26, v5, s[44:47], s63 offen
    s_add_u32 s63, s61, 99456
    buffer_load_ushort v54, v5, s[44:47], s63 offen
    s_add_u32 s63, s61, 102144
    buffer_load_ushort v27, v5, s[44:47], s63 offen
    s_add_u32 s63, s61, 104832
    buffer_load_ushort v55, v5, s[44:47], s63 offen
    s_add_u32 s63, s61, 129024
    buffer_load_ushort v28, v5, s[44:47], s63 offen
    s_add_u32 s63, s61, 131712
    buffer_load_ushort v56, v5, s[44:47], s63 offen
    s_add_u32 s63, s61, 134400
    buffer_load_ushort v29, v5, s[44:47], s63 offen
    s_add_u32 s63, s61, 137088
    buffer_load_ushort v57, v5, s[44:47], s63 offen
    s_add_u32 s63, s61, 139776
    buffer_load_ushort v30, v5, s[44:47], s63 offen
    s_add_u32 s63, s61, 142464
    buffer_load_ushort v58, v5, s[44:47], s63 offen
    s_add_u32 s63, s61, 145152
    buffer_load_ushort v31, v5, s[44:47], s63 offen
    s_add_u32 s63, s61, 147840
    buffer_load_ushort v59, v5, s[44:47], s63 offen
    s_add_u32 s63, s61, 172032
    buffer_load_ushort v32, v5, s[44:47], s63 offen
    s_add_u32 s63, s61, 174720
    buffer_load_ushort v60, v5, s[44:47], s63 offen
    s_add_u32 s63, s61, 177408
    buffer_load_ushort v33, v5, s[44:47], s63 offen
    s_add_u32 s63, s61, 180096
    buffer_load_ushort v61, v5, s[44:47], s63 offen
    s_add_u32 s63, s61, 182784
    buffer_load_ushort v34, v5, s[44:47], s63 offen
    s_add_u32 s63, s61, 185472
    buffer_load_ushort v62, v5, s[44:47], s63 offen
    s_add_u32 s63, s61, 188160
    buffer_load_ushort v35, v5, s[44:47], s63 offen
    s_add_u32 s63, s61, 190848
    buffer_load_ushort v63, v5, s[44:47], s63 offen
    s_add_u32 s63, s61, 215040
    buffer_load_ushort v36, v5, s[44:47], s63 offen
    s_add_u32 s63, s61, 217728
    buffer_load_ushort v64, v5, s[44:47], s63 offen
    s_add_u32 s63, s61, 220416
    buffer_load_ushort v37, v5, s[44:47], s63 offen
    s_add_u32 s63, s61, 223104
    buffer_load_ushort v65, v5, s[44:47], s63 offen
    s_add_u32 s63, s61, 225792
    buffer_load_ushort v38, v5, s[44:47], s63 offen
    s_add_u32 s63, s61, 228480
    buffer_load_ushort v66, v5, s[44:47], s63 offen
    s_add_u32 s63, s61, 231168
    buffer_load_ushort v39, v5, s[44:47], s63 offen
    s_add_u32 s63, s61, 233856
    buffer_load_ushort v67, v5, s[44:47], s63 offen
    s_add_u32 s63, s61, 258048
    buffer_load_ushort v40, v5, s[44:47], s63 offen
    s_add_u32 s63, s61, 260736
    buffer_load_ushort v68, v5, s[44:47], s63 offen
    s_add_u32 s63, s61, 263424
    buffer_load_ushort v41, v5, s[44:47], s63 offen
    s_add_u32 s63, s61, 266112
    buffer_load_ushort v69, v5, s[44:47], s63 offen
    s_add_u32 s63, s61, 268800
    buffer_load_ushort v42, v5, s[44:47], s63 offen
    s_add_u32 s63, s61, 271488
    buffer_load_ushort v70, v5, s[44:47], s63 offen
    s_add_u32 s63, s61, 274176
    buffer_load_ushort v43, v5, s[44:47], s63 offen
    s_add_u32 s63, s61, 276864
    buffer_load_ushort v71, v5, s[44:47], s63 offen
    s_mov_b64 exec, -1
    v_lshlrev_b32 v10, 4, v1
    v_mul_u32_u24 v11, 7168, v2
    v_add_u32 v10, v10, v11
    s_mul_i32 s63, s60, 28672
    s_add_u32 s63, s63, 2097152
    s_waitcnt vmcnt(0)
    v_lshl_or_b32 v16, v44, 16, v16
    v_lshl_or_b32 v17, v45, 16, v17
    v_lshl_or_b32 v18, v46, 16, v18
    v_lshl_or_b32 v19, v47, 16, v19
    v_lshl_or_b32 v20, v48, 16, v20
    v_lshl_or_b32 v21, v49, 16, v21
    v_lshl_or_b32 v22, v50, 16, v22
    v_lshl_or_b32 v23, v51, 16, v23
    v_lshl_or_b32 v24, v52, 16, v24
    v_lshl_or_b32 v25, v53, 16, v25
    v_lshl_or_b32 v26, v54, 16, v26
    v_lshl_or_b32 v27, v55, 16, v27
    v_lshl_or_b32 v28, v56, 16, v28
    v_lshl_or_b32 v29, v57, 16, v29
    v_lshl_or_b32 v30, v58, 16, v30
    v_lshl_or_b32 v31, v59, 16, v31
    v_lshl_or_b32 v32, v60, 16, v32
    v_lshl_or_b32 v33, v61, 16, v33
    v_lshl_or_b32 v34, v62, 16, v34
    v_lshl_or_b32 v35, v63, 16, v35
    v_lshl_or_b32 v36, v64, 16, v36
    v_lshl_or_b32 v37, v65, 16, v37
    v_lshl_or_b32 v38, v66, 16, v38
    v_lshl_or_b32 v39, v67, 16, v39
    v_lshl_or_b32 v40, v68, 16, v40
    v_lshl_or_b32 v41, v69, 16, v41
    v_lshl_or_b32 v42, v70, 16, v42
    v_lshl_or_b32 v43, v71, 16, v43
    s_add_u32 s64, s63, 0
    buffer_store_dwordx4 v[16:19], v10, s[56:59], s64 offen
    s_add_u32 s64, s63, 1024
    buffer_store_dwordx4 v[20:23], v10, s[56:59], s64 offen
    s_add_u32 s64, s63, 2048
    buffer_store_dwordx4 v[24:27], v10, s[56:59], s64 offen
    s_add_u32 s64, s63, 3072
    buffer_store_dwordx4 v[28:31], v10, s[56:59], s64 offen
    s_add_u32 s64, s63, 4096
    buffer_store_dwordx4 v[32:35], v10, s[56:59], s64 offen
    s_add_u32 s64, s63, 5120
    buffer_store_dwordx4 v[36:39], v10, s[56:59], s64 offen
    s_add_u32 s64, s63, 6144
    buffer_store_dwordx4 v[40:43], v10, s[56:59], s64 offen
    s_endpgm
L_prep_wo:
    s_sub_u32 s60, s2, 112
    s_lshl_b32 s61, s60, 6
    v_mul_u32_u24 v5, 3584, v4
    v_lshlrev_b32 v6, 1, v3
    v_add_u32 v5, v5, v6
    v_mul_u32_u24 v6, 100352, v2
    v_add_u32 v5, v5, v6
    s_mov_b32 s66, 0xffffffff
    s_mov_b32 s67, 0
    v_mov_b32 v16, 0
    v_mov_b32 v17, 0
    v_mov_b32 v18, 0
    v_mov_b32 v19, 0
    v_mov_b32 v20, 0
    v_mov_b32 v21, 0
    v_mov_b32 v22, 0
    v_mov_b32 v23, 0
    v_mov_b32 v24, 0
    v_mov_b32 v25, 0
    v_mov_b32 v26, 0
    v_mov_b32 v27, 0
    v_mov_b32 v28, 0
    v_mov_b32 v29, 0
    v_mov_b32 v30, 0
    v_mov_b32 v31, 0
    v_mov_b32 v32, 0
    v_mov_b32 v33, 0
    v_mov_b32 v34, 0
    v_mov_b32 v35, 0
    v_mov_b32 v36, 0
    v_mov_b32 v37, 0
    v_mov_b32 v38, 0
    v_mov_b32 v39, 0
    v_mov_b32 v40, 0
    v_mov_b32 v41, 0
    v_mov_b32 v42, 0
    v_mov_b32 v43, 0
    v_mov_b32 v44, 0
    v_mov_b32 v45, 0
    v_mov_b32 v46, 0
    v_mov_b32 v47, 0
    v_mov_b32 v48, 0
    v_mov_b32 v49, 0
    v_mov_b32 v50, 0
    v_mov_b32 v51, 0
    v_mov_b32 v52, 0
    v_mov_b32 v53, 0
    v_mov_b32 v54, 0
    v_mov_b32 v55, 0
    v_mov_b32 v56, 0
    v_mov_b32 v57, 0
    v_mov_b32 v58, 0
    v_mov_b32 v59, 0
    v_mov_b32 v60, 0
    v_mov_b32 v61, 0
    v_mov_b32 v62, 0
    v_mov_b32 v63, 0
    v_mov_b32 v64, 0
    v_mov_b32 v65, 0
    v_mov_b32 v66, 0
    v_mov_b32 v67, 0
    v_mov_b32 v68, 0
    v_mov_b32 v69, 0
    v_mov_b32 v70, 0
    v_mov_b32 v71, 0
    v_mov_b32 v72, 0
    v_mov_b32 v73, 0
    v_mov_b32 v74, 0
    v_mov_b32 v75, 0
    v_mov_b32 v76, 0
    v_mov_b32 v77, 0
    v_mov_b32 v78, 0
    v_mov_b32 v79, 0
    s_add_u32 s63, s61, 0
    buffer_load_ushort v16, v5, s[48:51], s63 offen
    s_add_u32 s63, s61, 896
    buffer_load_ushort v48, v5, s[48:51], s63 offen
    s_add_u32 s63, s61, 1792
    buffer_load_ushort v17, v5, s[48:51], s63 offen
    s_add_u32 s63, s61, 2688
    buffer_load_ushort v49, v5, s[48:51], s63 offen
    s_add_u32 s63, s61, 7168
    buffer_load_ushort v18, v5, s[48:51], s63 offen
    s_add_u32 s63, s61, 8064
    buffer_load_ushort v50, v5, s[48:51], s63 offen
    s_add_u32 s63, s61, 8960
    buffer_load_ushort v19, v5, s[48:51], s63 offen
    s_add_u32 s63, s61, 9856
    buffer_load_ushort v51, v5, s[48:51], s63 offen
    s_add_u32 s63, s61, 14336
    buffer_load_ushort v20, v5, s[48:51], s63 offen
    s_add_u32 s63, s61, 15232
    buffer_load_ushort v52, v5, s[48:51], s63 offen
    s_add_u32 s63, s61, 16128
    buffer_load_ushort v21, v5, s[48:51], s63 offen
    s_add_u32 s63, s61, 17024
    buffer_load_ushort v53, v5, s[48:51], s63 offen
    s_mov_b64 exec, s[66:67]
    s_add_u32 s63, s61, 21504
    buffer_load_ushort v22, v5, s[48:51], s63 offen
    s_add_u32 s63, s61, 22400
    buffer_load_ushort v54, v5, s[48:51], s63 offen
    s_add_u32 s63, s61, 23296
    buffer_load_ushort v23, v5, s[48:51], s63 offen
    s_add_u32 s63, s61, 24192
    buffer_load_ushort v55, v5, s[48:51], s63 offen
    s_mov_b64 exec, -1
    s_add_u32 s63, s61, 25088
    buffer_load_ushort v24, v5, s[48:51], s63 offen
    s_add_u32 s63, s61, 25984
    buffer_load_ushort v56, v5, s[48:51], s63 offen
    s_add_u32 s63, s61, 26880
    buffer_load_ushort v25, v5, s[48:51], s63 offen
    s_add_u32 s63, s61, 27776
    buffer_load_ushort v57, v5, s[48:51], s63 offen
    s_add_u32 s63, s61, 32256
    buffer_load_ushort v26, v5, s[48:51], s63 offen
    s_add_u32 s63, s61, 33152
    buffer_load_ushort v58, v5, s[48:51], s63 offen
    s_add_u32 s63, s61, 34048
    buffer_load_ushort v27, v5, s[48:51], s63 offen
    s_add_u32 s63, s61, 34944
    buffer_load_ushort v59, v5, s[48:51], s63 offen
    s_add_u32 s63, s61, 39424
    buffer_load_ushort v28, v5, s[48:51], s63 offen
    s_add_u32 s63, s61, 40320
    buffer_load_ushort v60, v5, s[48:51], s63 offen
    s_add_u32 s63, s61, 41216
    buffer_load_ushort v29, v5, s[48:51], s63 offen
    s_add_u32 s63, s61, 42112
    buffer_load_ushort v61, v5, s[48:51], s63 offen
    s_mov_b64 exec, s[66:67]
    s_add_u32 s63, s61, 46592
    buffer_load_ushort v30, v5, s[48:51], s63 offen
    s_add_u32 s63, s61, 47488
    buffer_load_ushort v62, v5, s[48:51], s63 offen
    s_add_u32 s63, s61, 48384
    buffer_load_ushort v31, v5, s[48:51], s63 offen
    s_add_u32 s63, s61, 49280
    buffer_load_ushort v63, v5, s[48:51], s63 offen
    s_mov_b64 exec, -1
    s_add_u32 s63, s61, 50176
    buffer_load_ushort v32, v5, s[48:51], s63 offen
    s_add_u32 s63, s61, 51072
    buffer_load_ushort v64, v5, s[48:51], s63 offen
    s_add_u32 s63, s61, 51968
    buffer_load_ushort v33, v5, s[48:51], s63 offen
    s_add_u32 s63, s61, 52864
    buffer_load_ushort v65, v5, s[48:51], s63 offen
    s_add_u32 s63, s61, 57344
    buffer_load_ushort v34, v5, s[48:51], s63 offen
    s_add_u32 s63, s61, 58240
    buffer_load_ushort v66, v5, s[48:51], s63 offen
    s_add_u32 s63, s61, 59136
    buffer_load_ushort v35, v5, s[48:51], s63 offen
    s_add_u32 s63, s61, 60032
    buffer_load_ushort v67, v5, s[48:51], s63 offen
    s_add_u32 s63, s61, 64512
    buffer_load_ushort v36, v5, s[48:51], s63 offen
    s_add_u32 s63, s61, 65408
    buffer_load_ushort v68, v5, s[48:51], s63 offen
    s_add_u32 s63, s61, 66304
    buffer_load_ushort v37, v5, s[48:51], s63 offen
    s_add_u32 s63, s61, 67200
    buffer_load_ushort v69, v5, s[48:51], s63 offen
    s_mov_b64 exec, s[66:67]
    s_add_u32 s63, s61, 71680
    buffer_load_ushort v38, v5, s[48:51], s63 offen
    s_add_u32 s63, s61, 72576
    buffer_load_ushort v70, v5, s[48:51], s63 offen
    s_add_u32 s63, s61, 73472
    buffer_load_ushort v39, v5, s[48:51], s63 offen
    s_add_u32 s63, s61, 74368
    buffer_load_ushort v71, v5, s[48:51], s63 offen
    s_mov_b64 exec, -1
    s_add_u32 s63, s61, 75264
    buffer_load_ushort v40, v5, s[48:51], s63 offen
    s_add_u32 s63, s61, 76160
    buffer_load_ushort v72, v5, s[48:51], s63 offen
    s_add_u32 s63, s61, 77056
    buffer_load_ushort v41, v5, s[48:51], s63 offen
    s_add_u32 s63, s61, 77952
    buffer_load_ushort v73, v5, s[48:51], s63 offen
    s_add_u32 s63, s61, 82432
    buffer_load_ushort v42, v5, s[48:51], s63 offen
    s_add_u32 s63, s61, 83328
    buffer_load_ushort v74, v5, s[48:51], s63 offen
    s_add_u32 s63, s61, 84224
    buffer_load_ushort v43, v5, s[48:51], s63 offen
    s_add_u32 s63, s61, 85120
    buffer_load_ushort v75, v5, s[48:51], s63 offen
    s_add_u32 s63, s61, 89600
    buffer_load_ushort v44, v5, s[48:51], s63 offen
    s_add_u32 s63, s61, 90496
    buffer_load_ushort v76, v5, s[48:51], s63 offen
    s_add_u32 s63, s61, 91392
    buffer_load_ushort v45, v5, s[48:51], s63 offen
    s_add_u32 s63, s61, 92288
    buffer_load_ushort v77, v5, s[48:51], s63 offen
    s_mov_b64 exec, s[66:67]
    s_add_u32 s63, s61, 96768
    buffer_load_ushort v46, v5, s[48:51], s63 offen
    s_add_u32 s63, s61, 97664
    buffer_load_ushort v78, v5, s[48:51], s63 offen
    s_add_u32 s63, s61, 98560
    buffer_load_ushort v47, v5, s[48:51], s63 offen
    s_add_u32 s63, s61, 99456
    buffer_load_ushort v79, v5, s[48:51], s63 offen
    s_mov_b64 exec, -1
    v_lshlrev_b32 v10, 4, v1
    v_lshlrev_b32 v11, 13, v2
    v_add_u32 v10, v10, v11
    s_lshl_b32 s63, s60, 15
    s_add_u32 s63, s63, 3670016
    s_waitcnt vmcnt(0)
    v_lshl_or_b32 v16, v48, 16, v16
    v_lshl_or_b32 v17, v49, 16, v17
    v_lshl_or_b32 v18, v50, 16, v18
    v_lshl_or_b32 v19, v51, 16, v19
    v_lshl_or_b32 v20, v52, 16, v20
    v_lshl_or_b32 v21, v53, 16, v21
    v_lshl_or_b32 v22, v54, 16, v22
    v_lshl_or_b32 v23, v55, 16, v23
    v_lshl_or_b32 v24, v56, 16, v24
    v_lshl_or_b32 v25, v57, 16, v25
    v_lshl_or_b32 v26, v58, 16, v26
    v_lshl_or_b32 v27, v59, 16, v27
    v_lshl_or_b32 v28, v60, 16, v28
    v_lshl_or_b32 v29, v61, 16, v29
    v_lshl_or_b32 v30, v62, 16, v30
    v_lshl_or_b32 v31, v63, 16, v31
    v_lshl_or_b32 v32, v64, 16, v32
    v_lshl_or_b32 v33, v65, 16, v33
    v_lshl_or_b32 v34, v66, 16, v34
    v_lshl_or_b32 v35, v67, 16, v35
    v_lshl_or_b32 v36, v68, 16, v36
    v_lshl_or_b32 v37, v69, 16, v37
    v_lshl_or_b32 v38, v70, 16, v38
    v_lshl_or_b32 v39, v71, 16, v39
    v_lshl_or_b32 v40, v72, 16, v40
    v_lshl_or_b32 v41, v73, 16, v41
    v_lshl_or_b32 v42, v74, 16, v42
    v_lshl_or_b32 v43, v75, 16, v43
    v_lshl_or_b32 v44, v76, 16, v44
    v_lshl_or_b32 v45, v77, 16, v45
    v_lshl_or_b32 v46, v78, 16, v46
    v_lshl_or_b32 v47, v79, 16, v47
    s_add_u32 s64, s63, 0
    buffer_store_dwordx4 v[16:19], v10, s[56:59], s64 offen
    s_add_u32 s64, s63, 1024
    buffer_store_dwordx4 v[20:23], v10, s[56:59], s64 offen
    s_add_u32 s64, s63, 2048
    buffer_store_dwordx4 v[24:27], v10, s[56:59], s64 offen
    s_add_u32 s64, s63, 3072
    buffer_store_dwordx4 v[28:31], v10, s[56:59], s64 offen
    s_add_u32 s64, s63, 4096
    buffer_store_dwordx4 v[32:35], v10, s[56:59], s64 offen
    s_add_u32 s64, s63, 5120
    buffer_store_dwordx4 v[36:39], v10, s[56:59], s64 offen
    s_add_u32 s64, s63, 6144
    buffer_store_dwordx4 v[40:43], v10, s[56:59], s64 offen
    s_add_u32 s64, s63, 7168
    buffer_store_dwordx4 v[44:47], v10, s[56:59], s64 offen
    s_endpgm
.section .rodata,"a"
.p2align 6
.amdhsa_kernel prep_kernel
  .amdhsa_next_free_vgpr 96
  .amdhsa_next_free_sgpr 102
  .amdhsa_accum_offset 96
  .amdhsa_group_segment_fixed_size 0
  .amdhsa_kernarg_size 88
  .amdhsa_user_sgpr_count 2
  .amdhsa_user_sgpr_kernarg_segment_ptr 1
  .amdhsa_system_sgpr_workgroup_id_x 1
.end_amdhsa_kernel
.text
.globl qkv_kernel
.p2align 8
.type qkv_kernel,@function
qkv_kernel:
    s_cmp_ge_u32 s2, 256
    s_cbranch_scc1 L_qkv_mod
    s_load_dwordx16 s[16:31], s[0:1], 0
    s_load_dwordx4 s[32:35], s[0:1], 64
    s_load_dwordx2 s[36:37], s[0:1], 80
    s_and_b32 s4, s2, 7
    s_lshl_b32 s4, s4, 1
    s_lshr_b32 s5, s2, 3
    s_lshr_b32 s3, s5, 4
    s_add_u32 s4, s4, s3
    s_and_b32 s5, s5, 15
    v_and_b32 v1, 63, v0
    v_lshrrev_b32 v2, 6, v0
    v_lshlrev_b32 v3, 4, v1
    v_readfirstlane_b32 s6, v2
    s_waitcnt lgkmcnt(0)
    s_mov_b32 s56, s36
    s_and_b32 s57, s37, 0xffff
    s_mov_b32 s58, 16777216
    s_mov_b32 s59, 0x00020000
    s_mul_i32 s8, s4, 28672
    s_add_u32 s8, s8, 2097152
    s_lshl_b32 s7, s6, 10
    s_add_u32 s9, s6, 0
    s_cmp_ge_u32 s9, 21
    s_cselect_b32 s9, s6, s9
    s_mul_hi_u32 s10, s9, 0x55555556
    s_mul_i32 s16, s10, 3
    s_sub_u32 s16, s9, s16
    s_mul_i32 s16, s16, 458752
    s_lshl_b32 s10, s10, 10
    s_add_u32 s16, s16, s10
    s_add_u32 s16, s16, s8
    s_lshl_b32 s9, s9, 10
    s_add_u32 s9, s9, 0
    s_mov_b32 m0, s9
    s_add_u32 s16, s16, 0
    buffer_load_dwordx4 v3, s[56:59], s16 offen lds
    s_add_u32 s9, s6, 4
    s_cmp_ge_u32 s9, 21
    s_cselect_b32 s9, s6, s9
    s_mul_hi_u32 s10, s9, 0x55555556
    s_mul_i32 s16, s10, 3
    s_sub_u32 s16, s9, s16
    s_mul_i32 s16, s16, 458752
    s_lshl_b32 s10, s10, 10
    s_add_u32 s16, s16, s10
    s_add_u32 s16, s16, s8
    s_lshl_b32 s9, s9, 10
    s_add_u32 s9, s9, 0
    s_mov_b32 m0, s9
    s_add_u32 s16, s16, 0
    buffer_load_dwordx4 v3, s[56:59], s16 offen lds
    s_add_u32 s9, s6, 8
    s_cmp_ge_u32 s9, 21
    s_cselect_b32 s9, s6, s9
    s_mul_hi_u32 s10, s9, 0x55555556
    s_mul_i32 s16, s10, 3
    s_sub_u32 s16, s9, s16
    s_mul_i32 s16, s16, 458752
    s_lshl_b32 s10, s10, 10
    s_add_u32 s16, s16, s10
    s_add_u32 s16, s16, s8
    s_lshl_b32 s9, s9, 10
    s_add_u32 s9, s9, 0
    s_mov_b32 m0, s9
    s_add_u32 s16, s16, 0
    buffer_load_dwordx4 v3, s[56:59], s16 offen lds
    s_add_u32 s9, s6, 12
    s_cmp_ge_u32 s9, 21
    s_cselect_b32 s9, s6, s9
    s_mul_hi_u32 s10, s9, 0x55555556
    s_mul_i32 s16, s10, 3
    s_sub_u32 s16, s9, s16
    s_mul_i32 s16, s16, 458752
    s_lshl_b32 s10, s10, 10
    s_add_u32 s16, s16, s10
    s_add_u32 s16, s16, s8
    s_lshl_b32 s9, s9, 10
    s_add_u32 s9, s9, 0
    s_mov_b32 m0, s9
    s_add_u32 s16, s16, 0
    buffer_load_dwordx4 v3, s[56:59], s16 offen lds
    s_add_u32 s9, s6, 16
    s_cmp_ge_u32 s9, 21
    s_cselect_b32 s9, s6, s9
    s_mul_hi_u32 s10, s9, 0x55555556
    s_mul_i32 s16, s10, 3
    s_sub_u32 s16, s9, s16
    s_mul_i32 s16, s16, 458752
    s_lshl_b32 s10, s10, 10
    s_add_u32 s16, s16, s10
    s_add_u32 s16, s16, s8
    s_lshl_b32 s9, s9, 10
    s_add_u32 s9, s9, 0
    s_mov_b32 m0, s9
    s_add_u32 s16, s16, 0
    buffer_load_dwordx4 v3, s[56:59], s16 offen lds
    s_add_u32 s9, s6, 20
    s_cmp_ge_u32 s9, 21
    s_cselect_b32 s9, s6, s9
    s_mul_hi_u32 s10, s9, 0x55555556
    s_mul_i32 s16, s10, 3
    s_sub_u32 s16, s9, s16
    s_mul_i32 s16, s16, 458752
    s_lshl_b32 s10, s10, 10
    s_add_u32 s16, s16, s10
    s_add_u32 s16, s16, s8
    s_lshl_b32 s9, s9, 10
    s_add_u32 s9, s9, 0
    s_mov_b32 m0, s9
    s_add_u32 s16, s16, 0
    buffer_load_dwordx4 v3, s[56:59], s16 offen lds
    s_add_u32 s9, s6, 0
    s_cmp_ge_u32 s9, 21
    s_cselect_b32 s9, s6, s9
    s_mul_hi_u32 s10, s9, 0x55555556
    s_mul_i32 s16, s10, 3
    s_sub_u32 s16, s9, s16
    s_mul_i32 s16, s16, 458752
    s_lshl_b32 s10, s10, 10
    s_add_u32 s16, s16, s10
    s_add_u32 s16, s16, s8
    s_lshl_b32 s9, s9, 10
    s_add_u32 s9, s9, 21504
    s_mov_b32 m0, s9
    s_add_u32 s16, s16, 7168
    buffer_load_dwordx4 v3, s[56:59], s16 offen lds
    s_add_u32 s9, s6, 4
    s_cmp_ge_u32 s9, 21
    s_cselect_b32 s9, s6, s9
    s_mul_hi_u32 s10, s9, 0x55555556
    s_mul_i32 s16, s10, 3
    s_sub_u32 s16, s9, s16
    s_mul_i32 s16, s16, 458752
    s_lshl_b32 s10, s10, 10
    s_add_u32 s16, s16, s10
    s_add_u32 s16, s16, s8
    s_lshl_b32 s9, s9, 10
    s_add_u32 s9, s9, 21504
    s_mov_b32 m0, s9
    s_add_u32 s16, s16, 7168
    buffer_load_dwordx4 v3, s[56:59], s16 offen lds
    s_add_u32 s9, s6, 8
    s_cmp_ge_u32 s9, 21
    s_cselect_b32 s9, s6, s9
    s_mul_hi_u32 s10, s9, 0x55555556
    s_mul_i32 s16, s10, 3
    s_sub_u32 s16, s9, s16
    s_mul_i32 s16, s16, 458752
    s_lshl_b32 s10, s10, 10
    s_add_u32 s16, s16, s10
    s_add_u32 s16, s16, s8
    s_lshl_b32 s9, s9, 10
    s_add_u32 s9, s9, 21504
    s_mov_b32 m0, s9
    s_add_u32 s16, s16, 7168
    buffer_load_dwordx4 v3, s[56:59], s16 offen lds
    s_add_u32 s9, s6, 12
    s_cmp_ge_u32 s9, 21
    s_cselect_b32 s9, s6, s9
    s_mul_hi_u32 s10, s9, 0x55555556
    s_mul_i32 s16, s10, 3
    s_sub_u32 s16, s9, s16
    s_mul_i32 s16, s16, 458752
    s_lshl_b32 s10, s10, 10
    s_add_u32 s16, s16, s10
    s_add_u32 s16, s16, s8
    s_lshl_b32 s9, s9, 10
    s_add_u32 s9, s9, 21504
    s_mov_b32 m0, s9
    s_add_u32 s16, s16, 7168
    buffer_load_dwordx4 v3, s[56:59], s16 offen lds
    s_add_u32 s9, s6, 16
    s_cmp_ge_u32 s9, 21
    s_cselect_b32 s9, s6, s9
    s_mul_hi_u32 s10, s9, 0x55555556
    s_mul_i32 s16, s10, 3
    s_sub_u32 s16, s9, s16
    s_mul_i32 s16, s16, 458752
    s_lshl_b32 s10, s10, 10
    s_add_u32 s16, s16, s10
    s_add_u32 s16, s16, s8
    s_lshl_b32 s9, s9, 10
    s_add_u32 s9, s9, 21504
    s_mov_b32 m0, s9
    s_add_u32 s16, s16, 7168
    buffer_load_dwordx4 v3, s[56:59], s16 offen lds
    s_add_u32 s9, s6, 20
    s_cmp_ge_u32 s9, 21
    s_cselect_b32 s9, s6, s9
    s_mul_hi_u32 s10, s9, 0x55555556
    s_mul_i32 s16, s10, 3
    s_sub_u32 s16, s9, s16
    s_mul_i32 s16, s16, 458752
    s_lshl_b32 s10, s10, 10
    s_add_u32 s16, s16, s10
    s_add_u32 s16, s16, s8
    s_lshl_b32 s9, s9, 10
    s_add_u32 s9, s9, 21504
    s_mov_b32 m0, s9
    s_add_u32 s16, s16, 7168
    buffer_load_dwordx4 v3, s[56:59], s16 offen lds
    s_lshl_b32 s11, s5, 2
    s_add_u32 s11, s11, s6
    s_mul_i32 s12, s11, 28672
    s_add_u32 s12, s12, 0
    s_add_u32 s13, s12, 0
    buffer_load_dwordx4 v[64:67], v3, s[56:59], s13 offen
    s_add_u32 s13, s12, 1024
    buffer_load_dwordx4 v[68:71], v3, s[56:59], s13 offen
    s_add_u32 s13, s12, 2048
    buffer_load_dwordx4 v[72:75], v3, s[56:59], s13 offen
    s_add_u32 s13, s12, 3072
    buffer_load_dwordx4 v[76:79], v3, s[56:59], s13 offen
    s_add_u32 s13, s12, 4096
    buffer_load_dwordx4 v[80:83], v3, s[56:59], s13 offen
    s_add_u32 s13, s12, 5120
    buffer_load_dwordx4 v[84:87], v3, s[56:59], s13 offen
    s_add_u32 s13, s12, 6144
    buffer_load_dwordx4 v[88:91], v3, s[56:59], s13 offen
    s_add_u32 s13, s12, 7168
    buffer_load_dwordx4 v[92:95], v3, s[56:59], s13 offen
    s_add_u32 s13, s12, 8192
    buffer_load_dwordx4 v[96:99], v3, s[56:59], s13 offen
    s_add_u32 s13, s12, 9216
    buffer_load_dwordx4 v[100:103], v3, s[56:59], s13 offen
    s_add_u32 s13, s12, 10240
    buffer_load_dwordx4 v[104:107], v3, s[56:59], s13 offen
    s_add_u32 s13, s12, 11264
    buffer_load_dwordx4 v[108:111], v3, s[56:59], s13 offen
    s_add_u32 s13, s12, 12288
    buffer_load_dwordx4 v[112:115], v3, s[56:59], s13 offen
    s_add_u32 s13, s12, 13312
    buffer_load_dwordx4 v[116:119], v3, s[56:59], s13 offen
    s_add_u32 s13, s12, 14336
    buffer_load_dwordx4 v[120:123], v3, s[56:59], s13 offen
    s_add_u32 s13, s12, 15360
    buffer_load_dwordx4 v[124:127], v3, s[56:59], s13 offen
    s_add_u32 s13, s12, 16384
    buffer_load_dwordx4 v[128:131], v3, s[56:59], s13 offen
    s_add_u32 s13, s12, 17408
    buffer_load_dwordx4 v[132:135], v3, s[56:59], s13 offen
    s_add_u32 s13, s12, 18432
    buffer_load_dwordx4 v[136:139], v3, s[56:59], s13 offen
    s_add_u32 s13, s12, 19456
    buffer_load_dwordx4 v[140:143], v3, s[56:59], s13 offen
    s_add_u32 s13, s12, 20480
    buffer_load_dwordx4 v[144:147], v3, s[56:59], s13 offen
    s_add_u32 s13, s12, 21504
    buffer_load_dwordx4 v[148:151], v3, s[56:59], s13 offen
    s_add_u32 s13, s12, 22528
    buffer_load_dwordx4 v[152:155], v3, s[56:59], s13 offen
    s_add_u32 s13, s12, 23552
    buffer_load_dwordx4 v[156:159], v3, s[56:59], s13 offen
    s_add_u32 s13, s12, 24576
    buffer_load_dwordx4 v[160:163], v3, s[56:59], s13 offen
    s_add_u32 s13, s12, 25600
    buffer_load_dwordx4 v[164:167], v3, s[56:59], s13 offen
    s_add_u32 s13, s12, 26624
    buffer_load_dwordx4 v[168:171], v3, s[56:59], s13 offen
    s_add_u32 s13, s12, 27648
    buffer_load_dwordx4 v[172:175], v3, s[56:59], s13 offen
    v_mov_b32 v16, 0
    v_mov_b32 v17, 0
    v_mov_b32 v18, 0
    v_mov_b32 v19, 0
    v_mov_b32 v20, 0
    v_mov_b32 v21, 0
    v_mov_b32 v22, 0
    v_mov_b32 v23, 0
    v_mov_b32 v24, 0
    v_mov_b32 v25, 0
    v_mov_b32 v26, 0
    v_mov_b32 v27, 0
    v_mov_b32 v28, 0
    v_mov_b32 v29, 0
    v_mov_b32 v30, 0
    v_mov_b32 v31, 0
    v_mov_b32 v32, 0
    v_mov_b32 v33, 0
    v_mov_b32 v34, 0
    v_mov_b32 v35, 0
    v_mov_b32 v36, 0
    v_mov_b32 v37, 0
    v_mov_b32 v38, 0
    v_mov_b32 v39, 0
    v_mov_b32 v40, 0
    v_mov_b32 v41, 0
    v_mov_b32 v42, 0
    v_mov_b32 v43, 0
    v_mov_b32 v44, 0
    v_mov_b32 v45, 0
    v_mov_b32 v46, 0
    v_mov_b32 v47, 0
    v_mov_b32 v48, 0
    v_mov_b32 v49, 0
    v_mov_b32 v50, 0
    v_mov_b32 v51, 0
    v_mov_b32 v52, 0
    v_mov_b32 v53, 0
    v_mov_b32 v54, 0
    v_mov_b32 v55, 0
    v_mov_b32 v56, 0
    v_mov_b32 v57, 0
    v_mov_b32 v58, 0
    v_mov_b32 v59, 0
    v_mov_b32 v60, 0
    v_mov_b32 v61, 0
    v_mov_b32 v62, 0
    v_mov_b32 v63, 0
    s_waitcnt vmcnt(28)
    s_barrier
    ds_read_b128 v[176:179], v3 offset:0
    ds_read_b128 v[180:183], v3 offset:1024
    ds_read_b128 v[184:187], v3 offset:2048
    ds_read_b128 v[188:191], v3 offset:3072
    ds_read_b128 v[192:195], v3 offset:4096
    ds_read_b128 v[196:199], v3 offset:5120
    s_waitcnt vmcnt(27) lgkmcnt(3)
    v_mfma_f32_32x32x16_bf16 v[16:31], v[176:179], v[64:67], v[16:31]
    v_mfma_f32_32x32x16_bf16 v[32:47], v[180:183], v[64:67], v[32:47]
    v_mfma_f32_32x32x16_bf16 v[48:63], v[64:67], v[184:187], v[48:63]
    ds_read_b128 v[176:179], v3 offset:6144
    ds_read_b128 v[180:183], v3 offset:7168
    ds_read_b128 v[184:187], v3 offset:8192
    s_waitcnt vmcnt(26) lgkmcnt(3)
    v_mfma_f32_32x32x16_bf16 v[16:31], v[188:191], v[68:71], v[16:31]
    v_mfma_f32_32x32x16_bf16 v[32:47], v[192:195], v[68:71], v[32:47]
    v_mfma_f32_32x32x16_bf16 v[48:63], v[68:71], v[196:199], v[48:63]
    ds_read_b128 v[188:191], v3 offset:9216
    ds_read_b128 v[192:195], v3 offset:10240
    ds_read_b128 v[196:199], v3 offset:11264
    s_waitcnt vmcnt(25) lgkmcnt(3)
    v_mfma_f32_32x32x16_bf16 v[16:31], v[176:179], v[72:75], v[16:31]
    v_mfma_f32_32x32x16_bf16 v[32:47], v[180:183], v[72:75], v[32:47]
    v_mfma_f32_32x32x16_bf16 v[48:63], v[72:75], v[184:187], v[48:63]
    ds_read_b128 v[176:179], v3 offset:12288
    ds_read_b128 v[180:183], v3 offset:13312
    ds_read_b128 v[184:187], v3 offset:14336
    s_waitcnt vmcnt(24) lgkmcnt(3)
    v_mfma_f32_32x32x16_bf16 v[16:31], v[188:191], v[76:79], v[16:31]
    v_mfma_f32_32x32x16_bf16 v[32:47], v[192:195], v[76:79], v[32:47]
    v_mfma_f32_32x32x16_bf16 v[48:63], v[76:79], v[196:199], v[48:63]
    ds_read_b128 v[188:191], v3 offset:15360
    ds_read_b128 v[192:195], v3 offset:16384
    ds_read_b128 v[196:199], v3 offset:17408
    s_waitcnt vmcnt(23) lgkmcnt(3)
    v_mfma_f32_32x32x16_bf16 v[16:31], v[176:179], v[80:83], v[16:31]
    v_mfma_f32_32x32x16_bf16 v[32:47], v[180:183], v[80:83], v[32:47]
    v_mfma_f32_32x32x16_bf16 v[48:63], v[80:83], v[184:187], v[48:63]
    ds_read_b128 v[176:179], v3 offset:18432
    ds_read_b128 v[180:183], v3 offset:19456
    ds_read_b128 v[184:187], v3 offset:20480
    s_waitcnt vmcnt(22) lgkmcnt(3)
    v_mfma_f32_32x32x16_bf16 v[16:31], v[188:191], v[84:87], v[16:31]
    v_mfma_f32_32x32x16_bf16 v[32:47], v[192:195], v[84:87], v[32:47]
    v_mfma_f32_32x32x16_bf16 v[48:63], v[84:87], v[196:199], v[48:63]
    s_waitcnt vmcnt(21) lgkmcnt(0)
    v_mfma_f32_32x32x16_bf16 v[16:31], v[176:179], v[88:91], v[16:31]
    v_mfma_f32_32x32x16_bf16 v[32:47], v[180:183], v[88:91], v[32:47]
    v_mfma_f32_32x32x16_bf16 v[48:63], v[88:91], v[184:187], v[48:63]
    s_barrier
    s_add_u32 s9, s6, 0
    s_cmp_ge_u32 s9, 21
    s_cselect_b32 s9, s6, s9
    s_mul_hi_u32 s10, s9, 0x55555556
    s_mul_i32 s16, s10, 3
    s_sub_u32 s16, s9, s16
    s_mul_i32 s16, s16, 458752
    s_lshl_b32 s10, s10, 10
    s_add_u32 s16, s16, s10
    s_add_u32 s16, s16, s8
    s_lshl_b32 s9, s9, 10
    s_add_u32 s9, s9, 0
    s_mov_b32 m0, s9
    s_add_u32 s16, s16, 14336
    buffer_load_dwordx4 v3, s[56:59], s16 offen lds
    s_add_u32 s9, s6, 4
    s_cmp_ge_u32 s9, 21
    s_cselect_b32 s9, s6, s9
    s_mul_hi_u32 s10, s9, 0x55555556
    s_mul_i32 s16, s10, 3
    s_sub_u32 s16, s9, s16
    s_mul_i32 s16, s16, 458752
    s_lshl_b32 s10, s10, 10
    s_add_u32 s16, s16, s10
    s_add_u32 s16, s16, s8
    s_lshl_b32 s9, s9, 10
    s_add_u32 s9, s9, 0
    s_mov_b32 m0, s9
    s_add_u32 s16, s16, 14336
    buffer_load_dwordx4 v3, s[56:59], s16 offen lds
    s_add_u32 s9, s6, 8
    s_cmp_ge_u32 s9, 21
    s_cselect_b32 s9, s6, s9
    s_mul_hi_u32 s10, s9, 0x55555556
    s_mul_i32 s16, s10, 3
    s_sub_u32 s16, s9, s16
    s_mul_i32 s16, s16, 458752
    s_lshl_b32 s10, s10, 10
    s_add_u32 s16, s16, s10
    s_add_u32 s16, s16, s8
    s_lshl_b32 s9, s9, 10
    s_add_u32 s9, s9, 0
    s_mov_b32 m0, s9
    s_add_u32 s16, s16, 14336
    buffer_load_dwordx4 v3, s[56:59], s16 offen lds
    s_add_u32 s9, s6, 12
    s_cmp_ge_u32 s9, 21
    s_cselect_b32 s9, s6, s9
    s_mul_hi_u32 s10, s9, 0x55555556
    s_mul_i32 s16, s10, 3
    s_sub_u32 s16, s9, s16
    s_mul_i32 s16, s16, 458752
    s_lshl_b32 s10, s10, 10
    s_add_u32 s16, s16, s10
    s_add_u32 s16, s16, s8
    s_lshl_b32 s9, s9, 10
    s_add_u32 s9, s9, 0
    s_mov_b32 m0, s9
    s_add_u32 s16, s16, 14336
    buffer_load_dwordx4 v3, s[56:59], s16 offen lds
    s_add_u32 s9, s6, 16
    s_cmp_ge_u32 s9, 21
    s_cselect_b32 s9, s6, s9
    s_mul_hi_u32 s10, s9, 0x55555556
    s_mul_i32 s16, s10, 3
    s_sub_u32 s16, s9, s16
    s_mul_i32 s16, s16, 458752
    s_lshl_b32 s10, s10, 10
    s_add_u32 s16, s16, s10
    s_add_u32 s16, s16, s8
    s_lshl_b32 s9, s9, 10
    s_add_u32 s9, s9, 0
    s_mov_b32 m0, s9
    s_add_u32 s16, s16, 14336
    buffer_load_dwordx4 v3, s[56:59], s16 offen lds
    s_add_u32 s9, s6, 20
    s_cmp_ge_u32 s9, 21
    s_cselect_b32 s9, s6, s9
    s_mul_hi_u32 s10, s9, 0x55555556
    s_mul_i32 s16, s10, 3
    s_sub_u32 s16, s9, s16
    s_mul_i32 s16, s16, 458752
    s_lshl_b32 s10, s10, 10
    s_add_u32 s16, s16, s10
    s_add_u32 s16, s16, s8
    s_lshl_b32 s9, s9, 10
    s_add_u32 s9, s9, 0
    s_mov_b32 m0, s9
    s_add_u32 s16, s16, 14336
    buffer_load_dwordx4 v3, s[56:59], s16 offen lds
    s_waitcnt vmcnt(6)
    s_barrier
    ds_read_b128 v[176:179], v3 offset:21504
    ds_read_b128 v[180:183], v3 offset:22528
    ds_read_b128 v[184:187], v3 offset:23552
    ds_read_b128 v[188:191], v3 offset:24576
    ds_read_b128 v[192:195], v3 offset:25600
    ds_read_b128 v[196:199], v3 offset:26624
    s_waitcnt lgkmcnt(3)
    v_mfma_f32_32x32x16_bf16 v[16:31], v[176:179], v[92:95], v[16:31]
    v_mfma_f32_32x32x16_bf16 v[32:47], v[180:183], v[92:95], v[32:47]
    v_mfma_f32_32x32x16_bf16 v[48:63], v[92:95], v[184:187], v[48:63]
    ds_read_b128 v[176:179], v3 offset:27648
    ds_read_b128 v[180:183], v3 offset:28672
    ds_read_b128 v[184:187], v3 offset:29696
    s_waitcnt lgkmcnt(3)
    v_mfma_f32_32x32x16_bf16 v[16:31], v[188:191], v[96:99], v[16:31]
    v_mfma_f32_32x32x16_bf16 v[32:47], v[192:195], v[96:99], v[32:47]
    v_mfma_f32_32x32x16_bf16 v[48:63], v[96:99], v[196:199], v[48:63]
    ds_read_b128 v[188:191], v3 offset:30720
    ds_read_b128 v[192:195], v3 offset:31744
    ds_read_b128 v[196:199], v3 offset:32768
    s_waitcnt lgkmcnt(3)
    v_mfma_f32_32x32x16_bf16 v[16:31], v[176:179], v[100:103], v[16:31]
    v_mfma_f32_32x32x16_bf16 v[32:47], v[180:183], v[100:103], v[32:47]
    v_mfma_f32_32x32x16_bf16 v[48:63], v[100:103], v[184:187], v[48:63]
    ds_read_b128 v[176:179], v3 offset:33792
    ds_read_b128 v[180:183], v3 offset:34816
    ds_read_b128 v[184:187], v3 offset:35840
    s_waitcnt lgkmcnt(3)
    v_mfma_f32_32x32x16_bf16 v[16:31], v[188:191], v[104:107], v[16:31]
    v_mfma_f32_32x32x16_bf16 v[32:47], v[192:195], v[104:107], v[32:47]
    v_mfma_f32_32x32x16_bf16 v[48:63], v[104:107], v[196:199], v[48:63]
    ds_read_b128 v[188:191], v3 offset:36864
    ds_read_b128 v[192:195], v3 offset:37888
    ds_read_b128 v[196:199], v3 offset:38912
    s_waitcnt lgkmcnt(3)
    v_mfma_f32_32x32x16_bf16 v[16:31], v[176:179], v[108:111], v[16:31]
    v_mfma_f32_32x32x16_bf16 v[32:47], v[180:183], v[108:111], v[32:47]
    v_mfma_f32_32x32x16_bf16 v[48:63], v[108:111], v[184:187], v[48:63]
    ds_read_b128 v[176:179], v3 offset:39936
    ds_read_b128 v[180:183], v3 offset:40960
    ds_read_b128 v[184:187], v3 offset:41984
    s_waitcnt lgkmcnt(3)
    v_mfma_f32_32x32x16_bf16 v[16:31], v[188:191], v[112:115], v[16:31]
    v_mfma_f32_32x32x16_bf16 v[32:47], v[192:195], v[112:115], v[32:47]
    v_mfma_f32_32x32x16_bf16 v[48:63], v[112:115], v[196:199], v[48:63]
    s_waitcnt lgkmcnt(0)
    v_mfma_f32_32x32x16_bf16 v[16:31], v[176:179], v[116:119], v[16:31]
    v_mfma_f32_32x32x16_bf16 v[32:47], v[180:183], v[116:119], v[32:47]
    v_mfma_f32_32x32x16_bf16 v[48:63], v[116:119], v[184:187], v[48:63]
    s_barrier
    s_add_u32 s9, s6, 0
    s_cmp_ge_u32 s9, 21
    s_cselect_b32 s9, s6, s9
    s_mul_hi_u32 s10, s9, 0x55555556
    s_mul_i32 s16, s10, 3
    s_sub_u32 s16, s9, s16
    s_mul_i32 s16, s16, 458752
    s_lshl_b32 s10, s10, 10
    s_add_u32 s16, s16, s10
    s_add_u32 s16, s16, s8
    s_lshl_b32 s9, s9, 10
    s_add_u32 s9, s9, 21504
    s_mov_b32 m0, s9
    s_add_u32 s16, s16, 21504
    buffer_load_dwordx4 v3, s[56:59], s16 offen lds
    s_add_u32 s9, s6, 4
    s_cmp_ge_u32 s9, 21
    s_cselect_b32 s9, s6, s9
    s_mul_hi_u32 s10, s9, 0x55555556
    s_mul_i32 s16, s10, 3
    s_sub_u32 s16, s9, s16
    s_mul_i32 s16, s16, 458752
    s_lshl_b32 s10, s10, 10
    s_add_u32 s16, s16, s10
    s_add_u32 s16, s16, s8
    s_lshl_b32 s9, s9, 10
    s_add_u32 s9, s9, 21504
    s_mov_b32 m0, s9
    s_add_u32 s16, s16, 21504
    buffer_load_dwordx4 v3, s[56:59], s16 offen lds
    s_add_u32 s9, s6, 8
    s_cmp_ge_u32 s9, 21
    s_cselect_b32 s9, s6, s9
    s_mul_hi_u32 s10, s9, 0x55555556
    s_mul_i32 s16, s10, 3
    s_sub_u32 s16, s9, s16
    s_mul_i32 s16, s16, 458752
    s_lshl_b32 s10, s10, 10
    s_add_u32 s16, s16, s10
    s_add_u32 s16, s16, s8
    s_lshl_b32 s9, s9, 10
    s_add_u32 s9, s9, 21504
    s_mov_b32 m0, s9
    s_add_u32 s16, s16, 21504
    buffer_load_dwordx4 v3, s[56:59], s16 offen lds
    s_add_u32 s9, s6, 12
    s_cmp_ge_u32 s9, 21
    s_cselect_b32 s9, s6, s9
    s_mul_hi_u32 s10, s9, 0x55555556
    s_mul_i32 s16, s10, 3
    s_sub_u32 s16, s9, s16
    s_mul_i32 s16, s16, 458752
    s_lshl_b32 s10, s10, 10
    s_add_u32 s16, s16, s10
    s_add_u32 s16, s16, s8
    s_lshl_b32 s9, s9, 10
    s_add_u32 s9, s9, 21504
    s_mov_b32 m0, s9
    s_add_u32 s16, s16, 21504
    buffer_load_dwordx4 v3, s[56:59], s16 offen lds
    s_add_u32 s9, s6, 16
    s_cmp_ge_u32 s9, 21
    s_cselect_b32 s9, s6, s9
    s_mul_hi_u32 s10, s9, 0x55555556
    s_mul_i32 s16, s10, 3
    s_sub_u32 s16, s9, s16
    s_mul_i32 s16, s16, 458752
    s_lshl_b32 s10, s10, 10
    s_add_u32 s16, s16, s10
    s_add_u32 s16, s16, s8
    s_lshl_b32 s9, s9, 10
    s_add_u32 s9, s9, 21504
    s_mov_b32 m0, s9
    s_add_u32 s16, s16, 21504
    buffer_load_dwordx4 v3, s[56:59], s16 offen lds
    s_add_u32 s9, s6, 20
    s_cmp_ge_u32 s9, 21
    s_cselect_b32 s9, s6, s9
    s_mul_hi_u32 s10, s9, 0x55555556
    s_mul_i32 s16, s10, 3
    s_sub_u32 s16, s9, s16
    s_mul_i32 s16, s16, 458752
    s_lshl_b32 s10, s10, 10
    s_add_u32 s16, s16, s10
    s_add_u32 s16, s16, s8
    s_lshl_b32 s9, s9, 10
    s_add_u32 s9, s9, 21504
    s_mov_b32 m0, s9
    s_add_u32 s16, s16, 21504
    buffer_load_dwordx4 v3, s[56:59], s16 offen lds
    s_waitcnt vmcnt(6)
    s_barrier
    ds_read_b128 v[176:179], v3 offset:0
    ds_read_b128 v[180:183], v3 offset:1024
    ds_read_b128 v[184:187], v3 offset:2048
    ds_read_b128 v[188:191], v3 offset:3072
    ds_read_b128 v[192:195], v3 offset:4096
    ds_read_b128 v[196:199], v3 offset:5120
    s_waitcnt lgkmcnt(3)
    v_mfma_f32_32x32x16_bf16 v[16:31], v[176:179], v[120:123], v[16:31]
    v_mfma_f32_32x32x16_bf16 v[32:47], v[180:183], v[120:123], v[32:47]
    v_mfma_f32_32x32x16_bf16 v[48:63], v[120:123], v[184:187], v[48:63]
    ds_read_b128 v[176:179], v3 offset:6144
    ds_read_b128 v[180:183], v3 offset:7168
    ds_read_b128 v[184:187], v3 offset:8192
    s_waitcnt lgkmcnt(3)
    v_mfma_f32_32x32x16_bf16 v[16:31], v[188:191], v[124:127], v[16:31]
    v_mfma_f32_32x32x16_bf16 v[32:47], v[192:195], v[124:127], v[32:47]
    v_mfma_f32_32x32x16_bf16 v[48:63], v[124:127], v[196:199], v[48:63]
    ds_read_b128 v[188:191], v3 offset:9216
    ds_read_b128 v[192:195], v3 offset:10240
    ds_read_b128 v[196:199], v3 offset:11264
    s_waitcnt lgkmcnt(3)
    v_mfma_f32_32x32x16_bf16 v[16:31], v[176:179], v[128:131], v[16:31]
    v_mfma_f32_32x32x16_bf16 v[32:47], v[180:183], v[128:131], v[32:47]
    v_mfma_f32_32x32x16_bf16 v[48:63], v[128:131], v[184:187], v[48:63]
    ds_read_b128 v[176:179], v3 offset:12288
    ds_read_b128 v[180:183], v3 offset:13312
    ds_read_b128 v[184:187], v3 offset:14336
    s_waitcnt lgkmcnt(3)
    v_mfma_f32_32x32x16_bf16 v[16:31], v[188:191], v[132:135], v[16:31]
    v_mfma_f32_32x32x16_bf16 v[32:47], v[192:195], v[132:135], v[32:47]
    v_mfma_f32_32x32x16_bf16 v[48:63], v[132:135], v[196:199], v[48:63]
    ds_read_b128 v[188:191], v3 offset:15360
    ds_read_b128 v[192:195], v3 offset:16384
    ds_read_b128 v[196:199], v3 offset:17408
    s_waitcnt lgkmcnt(3)
    v_mfma_f32_32x32x16_bf16 v[16:31], v[176:179], v[136:139], v[16:31]
    v_mfma_f32_32x32x16_bf16 v[32:47], v[180:183], v[136:139], v[32:47]
    v_mfma_f32_32x32x16_bf16 v[48:63], v[136:139], v[184:187], v[48:63]
    ds_read_b128 v[176:179], v3 offset:18432
    ds_read_b128 v[180:183], v3 offset:19456
    ds_read_b128 v[184:187], v3 offset:20480
    s_waitcnt lgkmcnt(3)
    v_mfma_f32_32x32x16_bf16 v[16:31], v[188:191], v[140:143], v[16:31]
    v_mfma_f32_32x32x16_bf16 v[32:47], v[192:195], v[140:143], v[32:47]
    v_mfma_f32_32x32x16_bf16 v[48:63], v[140:143], v[196:199], v[48:63]
    s_waitcnt lgkmcnt(0)
    v_mfma_f32_32x32x16_bf16 v[16:31], v[176:179], v[144:147], v[16:31]
    v_mfma_f32_32x32x16_bf16 v[32:47], v[180:183], v[144:147], v[32:47]
    v_mfma_f32_32x32x16_bf16 v[48:63], v[144:147], v[184:187], v[48:63]
    s_waitcnt vmcnt(0)
    s_barrier
    ds_read_b128 v[176:179], v3 offset:21504
    ds_read_b128 v[180:183], v3 offset:22528
    ds_read_b128 v[184:187], v3 offset:23552
    ds_read_b128 v[188:191], v3 offset:24576
    ds_read_b128 v[192:195], v3 offset:25600
    ds_read_b128 v[196:199], v3 offset:26624
    s_waitcnt lgkmcnt(3)
    v_mfma_f32_32x32x16_bf16 v[16:31], v[176:179], v[148:151], v[16:31]
    v_mfma_f32_32x32x16_bf16 v[32:47], v[180:183], v[148:151], v[32:47]
    v_mfma_f32_32x32x16_bf16 v[48:63], v[148:151], v[184:187], v[48:63]
    ds_read_b128 v[176:179], v3 offset:27648
    ds_read_b128 v[180:183], v3 offset:28672
    ds_read_b128 v[184:187], v3 offset:29696
    s_waitcnt lgkmcnt(3)
    v_mfma_f32_32x32x16_bf16 v[16:31], v[188:191], v[152:155], v[16:31]
    v_mfma_f32_32x32x16_bf16 v[32:47], v[192:195], v[152:155], v[32:47]
    v_mfma_f32_32x32x16_bf16 v[48:63], v[152:155], v[196:199], v[48:63]
    ds_read_b128 v[188:191], v3 offset:30720
    ds_read_b128 v[192:195], v3 offset:31744
    ds_read_b128 v[196:199], v3 offset:32768
    s_waitcnt lgkmcnt(3)
    v_mfma_f32_32x32x16_bf16 v[16:31], v[176:179], v[156:159], v[16:31]
    v_mfma_f32_32x32x16_bf16 v[32:47], v[180:183], v[156:159], v[32:47]
    v_mfma_f32_32x32x16_bf16 v[48:63], v[156:159], v[184:187], v[48:63]
    ds_read_b128 v[176:179], v3 offset:33792
    ds_read_b128 v[180:183], v3 offset:34816
    ds_read_b128 v[184:187], v3 offset:35840
    s_waitcnt lgkmcnt(3)
    v_mfma_f32_32x32x16_bf16 v[16:31], v[188:191], v[160:163], v[16:31]
    v_mfma_f32_32x32x16_bf16 v[32:47], v[192:195], v[160:163], v[32:47]
    v_mfma_f32_32x32x16_bf16 v[48:63], v[160:163], v[196:199], v[48:63]
    ds_read_b128 v[188:191], v3 offset:36864
    ds_read_b128 v[192:195], v3 offset:37888
    ds_read_b128 v[196:199], v3 offset:38912
    s_waitcnt lgkmcnt(3)
    v_mfma_f32_32x32x16_bf16 v[16:31], v[176:179], v[164:167], v[16:31]
    v_mfma_f32_32x32x16_bf16 v[32:47], v[180:183], v[164:167], v[32:47]
    v_mfma_f32_32x32x16_bf16 v[48:63], v[164:167], v[184:187], v[48:63]
    ds_read_b128 v[176:179], v3 offset:39936
    ds_read_b128 v[180:183], v3 offset:40960
    ds_read_b128 v[184:187], v3 offset:41984
    s_waitcnt lgkmcnt(3)
    v_mfma_f32_32x32x16_bf16 v[16:31], v[188:191], v[168:171], v[16:31]
    v_mfma_f32_32x32x16_bf16 v[32:47], v[192:195], v[168:171], v[32:47]
    v_mfma_f32_32x32x16_bf16 v[48:63], v[168:171], v[196:199], v[48:63]
    s_waitcnt lgkmcnt(0)
    v_mfma_f32_32x32x16_bf16 v[16:31], v[176:179], v[172:175], v[16:31]
    v_mfma_f32_32x32x16_bf16 v[32:47], v[180:183], v[172:175], v[32:47]
    v_mfma_f32_32x32x16_bf16 v[48:63], v[172:175], v[184:187], v[48:63]
    s_mov_b32 s14, 0x3e8b97f6
    s_mov_b32 s66, 0
    s_mov_b32 s67, 0xffffffff
    s_mov_b32 s68, 0x10000000
    s_mov_b32 s69, 0x10000000
    s_lshl_b32 s15, s4, 6
    s_add_u32 s15, s15, s11
    s_lshl_b32 s15, s15, 11
    s_nop 1
    v_mul_f32 v16, s14, v16
    v_mul_f32 v17, s14, v17
    v_mul_f32 v18, s14, v18
    v_mul_f32 v19, s14, v19
    v_mul_f32 v20, s14, v20
    v_mul_f32 v21, s14, v21
    v_mul_f32 v22, s14, v22
    v_mul_f32 v23, s14, v23
    v_mul_f32 v24, s14, v24
    v_mul_f32 v25, s14, v25
    v_mul_f32 v26, s14, v26
    v_mul_f32 v27, s14, v27
    v_mul_f32 v28, s14, v28
    v_mul_f32 v29, s14, v29
    v_mul_f32 v30, s14, v30
    v_mul_f32 v31, s14, v31
    s_mov_b64 exec, s[66:67]
    v_mov_b32 v44, 1.0
    s_mov_b64 exec, s[68:69]
    v_mov_b32 v48, 1.0
    v_mov_b32 v49, 1.0
    v_mov_b32 v50, 1.0
    v_mov_b32 v51, 1.0
    v_mov_b32 v52, 1.0
    v_mov_b32 v53, 1.0
    v_mov_b32 v54, 1.0
    v_mov_b32 v55, 1.0
    v_mov_b32 v56, 1.0
    v_mov_b32 v57, 1.0
    v_mov_b32 v58, 1.0
    v_mov_b32 v59, 1.0
    v_mov_b32 v60, 1.0
    v_mov_b32 v61, 1.0
    v_mov_b32 v62, 1.0
    v_mov_b32 v63, 1.0
    s_mov_b64 exec, -1
    v_cvt_pk_bf16_f32 v16, v16, v17
    v_cvt_pk_bf16_f32 v17, v18, v19
    v_cvt_pk_bf16_f32 v18, v20, v21
    v_cvt_pk_bf16_f32 v19, v22, v23
    v_cvt_pk_bf16_f32 v20, v24, v25
    v_cvt_pk_bf16_f32 v21, v26, v27
    v_cvt_pk_bf16_f32 v22, v28, v29
    v_cvt_pk_bf16_f32 v23, v30, v31
    s_add_u32 s13, s15, 6291456
    buffer_store_dwordx4 v[16:19], v3, s[56:59], s13 offen
    buffer_store_dwordx4 v[20:23], v3, s[56:59], s13 offen offset:1024
    v_cvt_pk_bf16_f32 v32, v32, v33
    v_cvt_pk_bf16_f32 v33, v34, v35
    v_cvt_pk_bf16_f32 v34, v36, v37
    v_cvt_pk_bf16_f32 v35, v38, v39
    v_cvt_pk_bf16_f32 v36, v40, v41
    v_cvt_pk_bf16_f32 v37, v42, v43
    v_cvt_pk_bf16_f32 v38, v44, v45
    v_cvt_pk_bf16_f32 v39, v46, v47
    s_add_u32 s13, s15, 8388608
    buffer_store_dwordx4 v[32:35], v3, s[56:59], s13 offen
    buffer_store_dwordx4 v[36:39], v3, s[56:59], s13 offen offset:1024
    v_cvt_pk_bf16_f32 v48, v48, v49
    v_cvt_pk_bf16_f32 v49, v50, v51
    v_cvt_pk_bf16_f32 v50, v52, v53
    v_cvt_pk_bf16_f32 v51, v54, v55
    v_cvt_pk_bf16_f32 v52, v56, v57
    v_cvt_pk_bf16_f32 v53, v58, v59
    v_cvt_pk_bf16_f32 v54, v60, v61
    v_cvt_pk_bf16_f32 v55, v62, v63
    s_add_u32 s13, s15, 10485760
    buffer_store_dwordx4 v[48:51], v3, s[56:59], s13 offen
    buffer_store_dwordx4 v[52:55], v3, s[56:59], s13 offen offset:1024
    s_endpgm
L_qkv_mod:
    s_endpgm
.section .rodata,"a"
.p2align 6
.amdhsa_kernel qkv_kernel
  .amdhsa_next_free_vgpr 200
  .amdhsa_next_free_sgpr 102
  .amdhsa_accum_offset 200
  .amdhsa_group_segment_fixed_size 0
  .amdhsa_kernarg_size 88
  .amdhsa_user_sgpr_count 2
  .amdhsa_user_sgpr_kernarg_segment_ptr 1
  .amdhsa_system_sgpr_workgroup_id_x 1
.end_amdhsa_kernel
.text
.globl attn_kernel
.p2align 8
.type attn_kernel,@function
attn_kernel:
    s_cmp_ge_u32 s2, 256
    s_cbranch_scc1 L_attn_mod
    s_load_dwordx16 s[16:31], s[0:1], 0
    s_load_dwordx4 s[32:35], s[0:1], 64
    s_load_dwordx2 s[36:37], s[0:1], 80
    s_and_b32 s4, s2, 7
    s_lshl_b32 s4, s4, 1
    s_lshr_b32 s5, s2, 3
    s_lshr_b32 s3, s5, 4
    s_add_u32 s4, s4, s3
    s_and_b32 s5, s5, 15
    v_and_b32 v1, 63, v0
    v_lshrrev_b32 v2, 6, v0
    v_lshlrev_b32 v3, 4, v1
    v_readfirstlane_b32 s6, v2
    s_waitcnt lgkmcnt(0)
    s_mov_b32 s56, s36
    s_and_b32 s57, s37, 0xffff
    s_mov_b32 s58, 16777216
    s_mov_b32 s59, 0x00020000
    s_and_b32 s7, s6, 3
    s_lshr_b32 s8, s6, 2
    s_lshl_b32 s9, s5, 2
    s_add_u32 s9, s9, s7
    s_lshl_b32 s10, s4, 6
    s_add_u32 s11, s10, s9
    s_lshl_b32 s11, s11, 11
    s_add_u32 s11, s11, 6291456
    s_lshl_b32 s12, s8, 5
    s_add_u32 s12, s12, s10
    s_lshl_b32 s12, s12, 11
    s_lshl_b32 s13, s7, 10
    s_add_u32 s12, s12, s13
    s_add_u32 s14, s12, 8388608
    s_add_u32 s15, s12, 10485760
    s_lshl_b32 s60, s8, 15
    s_add_u32 s61, s60, s13
    v_mov_b32 v4, s60
    v_add_u32 v4, v4, v3
    s_mov_b32 s66, 0
    s_mov_b32 s67, 0xffffffff
    buffer_load_dwordx4 v[8:11], v3, s[56:59], s11 offen
    buffer_load_dwordx4 v[12:15], v3, s[56:59], s11 offen offset:1024
    s_mov_b32 s70, s14
    s_mov_b32 s71, s15
    s_add_u32 s69, s61, 0
    s_mov_b32 m0, s69
    s_nop 0
    buffer_load_dwordx4 v3, s[56:59], s70 offen lds
    s_add_u32 s69, s61, 16384
    s_mov_b32 m0, s69
    s_nop 0
    buffer_load_dwordx4 v3, s[56:59], s71 offen lds
    s_add_u32 s70, s70, 4096
    s_add_u32 s69, s61, 4096
    s_mov_b32 m0, s69
    s_nop 0
    buffer_load_dwordx4 v3, s[56:59], s70 offen lds
    s_add_u32 s71, s71, 4096
    s_add_u32 s69, s61, 20480
    s_mov_b32 m0, s69
    s_nop 0
    buffer_load_dwordx4 v3, s[56:59], s71 offen lds
    s_add_u32 s70, s70, 4096
    s_add_u32 s69, s61, 8192
    s_mov_b32 m0, s69
    s_nop 0
    buffer_load_dwordx4 v3, s[56:59], s70 offen lds
    v_mov_b32 v16, 0
    v_mov_b32 v17, 0
    v_mov_b32 v18, 0
    v_mov_b32 v19, 0
    v_mov_b32 v20, 0
    v_mov_b32 v21, 0
    v_mov_b32 v22, 0
    v_mov_b32 v23, 0
    v_mov_b32 v24, 0
    v_mov_b32 v25, 0
    v_mov_b32 v26, 0
    v_mov_b32 v27, 0
    v_mov_b32 v28, 0
    v_mov_b32 v29, 0
    v_mov_b32 v30, 0
    v_mov_b32 v31, 0
    s_waitcnt vmcnt(0)
    s_barrier
    ds_read_b128 v[96:99], v4 offset:0
    ds_read_b128 v[100:103], v4 offset:1024
    ds_read_b128 v[104:107], v4 offset:2048
    ds_read_b128 v[108:111], v4 offset:3072
    s_waitcnt lgkmcnt(0)
    v_mfma_f32_32x32x16_bf16 v[32:47], v[96:99], v[8:11], 0
    v_mfma_f32_32x32x16_bf16 v[32:47], v[100:103], v[12:15], v[32:47]
    v_mfma_f32_32x32x16_bf16 v[48:63], v[104:107], v[8:11], 0
    v_mfma_f32_32x32x16_bf16 v[48:63], v[108:111], v[12:15], v[48:63]
    s_nop 9
    v_max3_f32 v6, v32, v33, v34
    v_max3_f32 v6, v6, v35, v36
    v_max3_f32 v6, v6, v37, v38
    v_max3_f32 v6, v6, v39, v40
    v_max3_f32 v6, v6, v41, v42
    v_max3_f32 v6, v6, v43, v44
    v_max3_f32 v6, v6, v45, v46
    v_max3_f32 v6, v6, v47, v48
    v_max3_f32 v6, v6, v49, v50
    v_max3_f32 v6, v6, v51, v52
    v_max3_f32 v6, v6, v53, v54
    v_max3_f32 v6, v6, v55, v56
    v_max3_f32 v6, v6, v57, v58
    v_max3_f32 v6, v6, v59, v60
    v_max3_f32 v6, v6, v61, v62
    v_max_f32 v6, v6, v63
    v_mov_b32 v7, v6
    s_nop 1
    v_permlane32_swap_b32 v6, v7
    v_max_f32 v6, v6, v7
    v_cvt_pk_bf16_f32 v7, v6, v6
    v_lshlrev_b32 v5, 16, v7
    v_xor_b32 v7, 0x8000, v7
    v_and_b32 v7, 0xffff, v7
    s_mov_b64 exec, s[66:67]
    v_mov_b32 v14, v7
    s_mov_b64 exec, -1
    v_mfma_f32_32x32x16_bf16 v[32:47], v[96:99], v[8:11], 0
    v_mfma_f32_32x32x16_bf16 v[32:47], v[100:103], v[12:15], v[32:47]
    v_mfma_f32_32x32x16_bf16 v[48:63], v[104:107], v[8:11], 0
    v_mfma_f32_32x32x16_bf16 v[48:63], v[108:111], v[12:15], v[48:63]
    s_barrier
    s_mov_b32 s72, 3
L_attn_loop_fast:
    ds_read_b128 v[96:99], v4 offset:4096
    ds_read_b128 v[100:103], v4 offset:5120
    ds_read_b128 v[104:107], v4 offset:6144
    ds_read_b128 v[108:111], v4 offset:7168
    ds_read_b128 v[112:115], v4 offset:16384
    ds_read_b128 v[116:119], v4 offset:17408
    ds_read_b128 v[120:123], v4 offset:18432
    ds_read_b128 v[124:127], v4 offset:19456
    s_add_u32 s70, s70, 4096
    s_add_u32 s69, s61, 12288
    s_mov_b32 m0, s69
    s_nop 0
    buffer_load_dwordx4 v3, s[56:59], s70 offen lds
    s_add_u32 s71, s71, 4096
    s_add_u32 s69, s61, 24576
    s_mov_b32 m0, s69
    s_nop 0
    buffer_load_dwordx4 v3, s[56:59], s71 offen lds
    s_add_u32 s70, s70, 4096
    s_add_u32 s69, s61, 0
    s_mov_b32 m0, s69
    s_nop 0
    buffer_load_dwordx4 v3, s[56:59], s70 offen lds
    s_add_u32 s71, s71, 4096
    s_add_u32 s69, s61, 28672
    s_mov_b32 m0, s69
    s_nop 0
    buffer_load_dwordx4 v3, s[56:59], s71 offen lds
    v_exp_f32 v32, v32
    v_exp_f32 v33, v33
    v_exp_f32 v34, v34
    v_exp_f32 v35, v35
    v_exp_f32 v36, v36
    v_exp_f32 v37, v37
    v_exp_f32 v38, v38
    v_exp_f32 v39, v39
    v_exp_f32 v40, v40
    v_exp_f32 v41, v41
    v_exp_f32 v42, v42
    v_exp_f32 v43, v43
    v_exp_f32 v44, v44
    v_exp_f32 v45, v45
    v_exp_f32 v46, v46
    v_exp_f32 v47, v47
    s_waitcnt lgkmcnt(4)
    v_mfma_f32_32x32x16_bf16 v[64:79], v[96:99], v[8:11], 0
    v_mfma_f32_32x32x16_bf16 v[64:79], v[100:103], v[12:15], v[64:79]
    v_mfma_f32_32x32x16_bf16 v[80:95], v[104:107], v[8:11], 0
    v_mfma_f32_32x32x16_bf16 v[80:95], v[108:111], v[12:15], v[80:95]
    v_cvt_pk_bf16_f32 v96, v32, v33
    v_cvt_pk_bf16_f32 v97, v34, v35
    v_cvt_pk_bf16_f32 v98, v36, v37
    v_cvt_pk_bf16_f32 v99, v38, v39
    v_cvt_pk_bf16_f32 v100, v40, v41
    v_cvt_pk_bf16_f32 v101, v42, v43
    v_cvt_pk_bf16_f32 v102, v44, v45
    v_cvt_pk_bf16_f32 v103, v46, v47
    v_exp_f32 v48, v48
    v_exp_f32 v49, v49
    v_exp_f32 v50, v50
    v_exp_f32 v51, v51
    v_exp_f32 v52, v52
    v_exp_f32 v53, v53
    v_exp_f32 v54, v54
    v_exp_f32 v55, v55
    s_waitcnt lgkmcnt(0)
    v_mfma_f32_32x32x16_bf16 v[16:31], v[112:115], v[96:99], v[16:31]
    v_exp_f32 v56, v56
    v_exp_f32 v57, v57
    v_exp_f32 v58, v58
    v_exp_f32 v59, v59
    v_mfma_f32_32x32x16_bf16 v[16:31], v[116:119], v[100:103], v[16:31]
    v_exp_f32 v60, v60
    v_exp_f32 v61, v61
    v_exp_f32 v62, v62
    v_exp_f32 v63, v63
    v_cvt_pk_bf16_f32 v104, v48, v49
    v_cvt_pk_bf16_f32 v105, v50, v51
    v_cvt_pk_bf16_f32 v106, v52, v53
    v_cvt_pk_bf16_f32 v107, v54, v55
    v_cvt_pk_bf16_f32 v108, v56, v57
    v_cvt_pk_bf16_f32 v109, v58, v59
    v_cvt_pk_bf16_f32 v110, v60, v61
    v_cvt_pk_bf16_f32 v111, v62, v63
    v_mfma_f32_32x32x16_bf16 v[16:31], v[120:123], v[104:107], v[16:31]
    s_nop 0
    v_mfma_f32_32x32x16_bf16 v[16:31], v[124:127], v[108:111], v[16:31]
    ds_read_b128 v[96:99], v4 offset:8192
    ds_read_b128 v[100:103], v4 offset:9216
    ds_read_b128 v[104:107], v4 offset:10240
    ds_read_b128 v[108:111], v4 offset:11264
    ds_read_b128 v[112:115], v4 offset:20480
    ds_read_b128 v[116:119], v4 offset:21504
    ds_read_b128 v[120:123], v4 offset:22528
    ds_read_b128 v[124:127], v4 offset:23552
    v_exp_f32 v64, v64
    v_exp_f32 v65, v65
    v_exp_f32 v66, v66
    v_exp_f32 v67, v67
    v_exp_f32 v68, v68
    v_exp_f32 v69, v69
    v_exp_f32 v70, v70
    v_exp_f32 v71, v71
    v_exp_f32 v72, v72
    v_exp_f32 v73, v73
    v_exp_f32 v74, v74
    v_exp_f32 v75, v75
    v_exp_f32 v76, v76
    v_exp_f32 v77, v77
    v_exp_f32 v78, v78
    v_exp_f32 v79, v79
    s_waitcnt lgkmcnt(4)
    v_mfma_f32_32x32x16_bf16 v[32:47], v[96:99], v[8:11], 0
    v_mfma_f32_32x32x16_bf16 v[32:47], v[100:103], v[12:15], v[32:47]
    v_mfma_f32_32x32x16_bf16 v[48:63], v[104:107], v[8:11], 0
    v_mfma_f32_32x32x16_bf16 v[48:63], v[108:111], v[12:15], v[48:63]
    v_cvt_pk_bf16_f32 v96, v64, v65
    v_cvt_pk_bf16_f32 v97, v66, v67
    v_cvt_pk_bf16_f32 v98, v68, v69
    v_cvt_pk_bf16_f32 v99, v70, v71
    v_cvt_pk_bf16_f32 v100, v72, v73
    v_cvt_pk_bf16_f32 v101, v74, v75
    v_cvt_pk_bf16_f32 v102, v76, v77
    v_cvt_pk_bf16_f32 v103, v78, v79
    v_exp_f32 v80, v80
    v_exp_f32 v81, v81
    v_exp_f32 v82, v82
    v_exp_f32 v83, v83
    v_exp_f32 v84, v84
    v_exp_f32 v85, v85
    v_exp_f32 v86, v86
    v_exp_f32 v87, v87
    s_waitcnt lgkmcnt(0)
    v_mfma_f32_32x32x16_bf16 v[16:31], v[112:115], v[96:99], v[16:31]
    v_exp_f32 v88, v88
    v_exp_f32 v89, v89
    v_exp_f32 v90, v90
    v_exp_f32 v91, v91
    v_mfma_f32_32x32x16_bf16 v[16:31], v[116:119], v[100:103], v[16:31]
    v_exp_f32 v92, v92
    v_exp_f32 v93, v93
    v_exp_f32 v94, v94
    v_exp_f32 v95, v95
    v_cvt_pk_bf16_f32 v104, v80, v81
    v_cvt_pk_bf16_f32 v105, v82, v83
    v_cvt_pk_bf16_f32 v106, v84, v85
    v_cvt_pk_bf16_f32 v107, v86, v87
    v_cvt_pk_bf16_f32 v108, v88, v89
    v_cvt_pk_bf16_f32 v109, v90, v91
    v_cvt_pk_bf16_f32 v110, v92, v93
    v_cvt_pk_bf16_f32 v111, v94, v95
    v_mfma_f32_32x32x16_bf16 v[16:31], v[120:123], v[104:107], v[16:31]
    s_nop 0
    v_mfma_f32_32x32x16_bf16 v[16:31], v[124:127], v[108:111], v[16:31]
    s_waitcnt vmcnt(0)
    s_barrier
    ds_read_b128 v[96:99], v4 offset:12288
    ds_read_b128 v[100:103], v4 offset:13312
    ds_read_b128 v[104:107], v4 offset:14336
    ds_read_b128 v[108:111], v4 offset:15360
    ds_read_b128 v[112:115], v4 offset:24576
    ds_read_b128 v[116:119], v4 offset:25600
    ds_read_b128 v[120:123], v4 offset:26624
    ds_read_b128 v[124:127], v4 offset:27648
    s_add_u32 s70, s70, 4096
    s_add_u32 s69, s61, 4096
    s_mov_b32 m0, s69
    s_nop 0
    buffer_load_dwordx4 v3, s[56:59], s70 offen lds
    s_add_u32 s71, s71, 4096
    s_add_u32 s69, s61, 16384
    s_mov_b32 m0, s69
    s_nop 0
    buffer_load_dwordx4 v3, s[56:59], s71 offen lds
    s_add_u32 s70, s70, 4096
    s_add_u32 s69, s61, 8192
    s_mov_b32 m0, s69
    s_nop 0
    buffer_load_dwordx4 v3, s[56:59], s70 offen lds
    s_add_u32 s71, s71, 4096
    s_add_u32 s69, s61, 20480
    s_mov_b32 m0, s69
    s_nop 0
    buffer_load_dwordx4 v3, s[56:59], s71 offen lds
    v_exp_f32 v32, v32
    v_exp_f32 v33, v33
    v_exp_f32 v34, v34
    v_exp_f32 v35, v35
    v_exp_f32 v36, v36
    v_exp_f32 v37, v37
    v_exp_f32 v38, v38
    v_exp_f32 v39, v39
    v_exp_f32 v40, v40
    v_exp_f32 v41, v41
    v_exp_f32 v42, v42
    v_exp_f32 v43, v43
    v_exp_f32 v44, v44
    v_exp_f32 v45, v45
    v_exp_f32 v46, v46
    v_exp_f32 v47, v47
    s_waitcnt lgkmcnt(4)
    v_mfma_f32_32x32x16_bf16 v[64:79], v[96:99], v[8:11], 0
    v_mfma_f32_32x32x16_bf16 v[64:79], v[100:103], v[12:15], v[64:79]
    v_mfma_f32_32x32x16_bf16 v[80:95], v[104:107], v[8:11], 0
    v_mfma_f32_32x32x16_bf16 v[80:95], v[108:111], v[12:15], v[80:95]
    v_cvt_pk_bf16_f32 v96, v32, v33
    v_cvt_pk_bf16_f32 v97, v34, v35
    v_cvt_pk_bf16_f32 v98, v36, v37
    v_cvt_pk_bf16_f32 v99, v38, v39
    v_cvt_pk_bf16_f32 v100, v40, v41
    v_cvt_pk_bf16_f32 v101, v42, v43
    v_cvt_pk_bf16_f32 v102, v44, v45
    v_cvt_pk_bf16_f32 v103, v46, v47
    v_exp_f32 v48, v48
    v_exp_f32 v49, v49
    v_exp_f32 v50, v50
    v_exp_f32 v51, v51
    v_exp_f32 v52, v52
    v_exp_f32 v53, v53
    v_exp_f32 v54, v54
    v_exp_f32 v55, v55
    s_waitcnt lgkmcnt(0)
    v_mfma_f32_32x32x16_bf16 v[16:31], v[112:115], v[96:99], v[16:31]
    v_exp_f32 v56, v56
    v_exp_f32 v57, v57
    v_exp_f32 v58, v58
    v_exp_f32 v59, v59
    v_mfma_f32_32x32x16_bf16 v[16:31], v[116:119], v[100:103], v[16:31]
    v_exp_f32 v60, v60
    v_exp_f32 v61, v61
    v_exp_f32 v62, v62
    v_exp_f32 v63, v63
    v_cvt_pk_bf16_f32 v104, v48, v49
    v_cvt_pk_bf16_f32 v105, v50, v51
    v_cvt_pk_bf16_f32 v106, v52, v53
    v_cvt_pk_bf16_f32 v107, v54, v55
    v_cvt_pk_bf16_f32 v108, v56, v57
    v_cvt_pk_bf16_f32 v109, v58, v59
    v_cvt_pk_bf16_f32 v110, v60, v61
    v_cvt_pk_bf16_f32 v111, v62, v63
    v_mfma_f32_32x32x16_bf16 v[16:31], v[120:123], v[104:107], v[16:31]
    s_nop 0
    v_mfma_f32_32x32x16_bf16 v[16:31], v[124:127], v[108:111], v[16:31]
    ds_read_b128 v[96:99], v4 offset:0
    ds_read_b128 v[100:103], v4 offset:1024
    ds_read_b128 v[104:107], v4 offset:2048
    ds_read_b128 v[108:111], v4 offset:3072
    ds_read_b128 v[112:115], v4 offset:28672
    ds_read_b128 v[116:119], v4 offset:29696
    ds_read_b128 v[120:123], v4 offset:30720
    ds_read_b128 v[124:127], v4 offset:31744
    v_exp_f32 v64, v64
    v_exp_f32 v65, v65
    v_exp_f32 v66, v66
    v_exp_f32 v67, v67
    v_exp_f32 v68, v68
    v_exp_f32 v69, v69
    v_exp_f32 v70, v70
    v_exp_f32 v71, v71
    v_exp_f32 v72, v72
    v_exp_f32 v73, v73
    v_exp_f32 v74, v74
    v_exp_f32 v75, v75
    v_exp_f32 v76, v76
    v_exp_f32 v77, v77
    v_exp_f32 v78, v78
    v_exp_f32 v79, v79
    s_waitcnt lgkmcnt(4)
    v_mfma_f32_32x32x16_bf16 v[32:47], v[96:99], v[8:11], 0
    v_mfma_f32_32x32x16_bf16 v[32:47], v[100:103], v[12:15], v[32:47]
    v_mfma_f32_32x32x16_bf16 v[48:63], v[104:107], v[8:11], 0
    v_mfma_f32_32x32x16_bf16 v[48:63], v[108:111], v[12:15], v[48:63]
    v_cvt_pk_bf16_f32 v96, v64, v65
    v_cvt_pk_bf16_f32 v97, v66, v67
    v_cvt_pk_bf16_f32 v98, v68, v69
    v_cvt_pk_bf16_f32 v99, v70, v71
    v_cvt_pk_bf16_f32 v100, v72, v73
    v_cvt_pk_bf16_f32 v101, v74, v75
    v_cvt_pk_bf16_f32 v102, v76, v77
    v_cvt_pk_bf16_f32 v103, v78, v79
    v_exp_f32 v80, v80
    v_exp_f32 v81, v81
    v_exp_f32 v82, v82
    v_exp_f32 v83, v83
    v_exp_f32 v84, v84
    v_exp_f32 v85, v85
    v_exp_f32 v86, v86
    v_exp_f32 v87, v87
    s_waitcnt lgkmcnt(0)
    v_mfma_f32_32x32x16_bf16 v[16:31], v[112:115], v[96:99], v[16:31]
    v_exp_f32 v88, v88
    v_exp_f32 v89, v89
    v_exp_f32 v90, v90
    v_exp_f32 v91, v91
    v_mfma_f32_32x32x16_bf16 v[16:31], v[116:119], v[100:103], v[16:31]
    v_exp_f32 v92, v92
    v_exp_f32 v93, v93
    v_exp_f32 v94, v94
    v_exp_f32 v95, v95
    v_cvt_pk_bf16_f32 v104, v80, v81
    v_cvt_pk_bf16_f32 v105, v82, v83
    v_cvt_pk_bf16_f32 v106, v84, v85
    v_cvt_pk_bf16_f32 v107, v86, v87
    v_cvt_pk_bf16_f32 v108, v88, v89
    v_cvt_pk_bf16_f32 v109, v90, v91
    v_cvt_pk_bf16_f32 v110, v92, v93
    v_cvt_pk_bf16_f32 v111, v94, v95
    v_mfma_f32_32x32x16_bf16 v[16:31], v[120:123], v[104:107], v[16:31]
    s_nop 0
    v_mfma_f32_32x32x16_bf16 v[16:31], v[124:127], v[108:111], v[16:31]
    s_waitcnt vmcnt(0)
    s_barrier
    s_sub_u32 s72, s72, 1
    s_cmp_lg_u32 s72, 0
    s_cbranch_scc1 L_attn_loop_fast
    ds_read_b128 v[96:99], v4 offset:4096
    ds_read_b128 v[100:103], v4 offset:5120
    ds_read_b128 v[104:107], v4 offset:6144
    ds_read_b128 v[108:111], v4 offset:7168
    ds_read_b128 v[112:115], v4 offset:16384
    ds_read_b128 v[116:119], v4 offset:17408
    ds_read_b128 v[120:123], v4 offset:18432
    ds_read_b128 v[124:127], v4 offset:19456
    s_add_u32 s70, s70, 4096
    s_add_u32 s69, s61, 12288
    s_mov_b32 m0, s69
    s_nop 0
    buffer_load_dwordx4 v3, s[56:59], s70 offen lds
    s_add_u32 s71, s71, 4096
    s_add_u32 s69, s61, 24576
    s_mov_b32 m0, s69
    s_nop 0
    buffer_load_dwordx4 v3, s[56:59], s71 offen lds
    s_add_u32 s70, s70, 4096
    s_add_u32 s69, s61, 0
    s_mov_b32 m0, s69
    s_nop 0
    buffer_load_dwordx4 v3, s[56:59], s70 offen lds
    s_add_u32 s71, s71, 4096
    s_add_u32 s69, s61, 28672
    s_mov_b32 m0, s69
    s_nop 0
    buffer_load_dwordx4 v3, s[56:59], s71 offen lds
    v_exp_f32 v32, v32
    v_exp_f32 v33, v33
    v_exp_f32 v34, v34
    v_exp_f32 v35, v35
    v_exp_f32 v36, v36
    v_exp_f32 v37, v37
    v_exp_f32 v38, v38
    v_exp_f32 v39, v39
    v_exp_f32 v40, v40
    v_exp_f32 v41, v41
    v_exp_f32 v42, v42
    v_exp_f32 v43, v43
    v_exp_f32 v44, v44
    v_exp_f32 v45, v45
    v_exp_f32 v46, v46
    v_exp_f32 v47, v47
    s_waitcnt lgkmcnt(4)
    v_mfma_f32_32x32x16_bf16 v[64:79], v[96:99], v[8:11], 0
    v_mfma_f32_32x32x16_bf16 v[64:79], v[100:103], v[12:15], v[64:79]
    v_mfma_f32_32x32x16_bf16 v[80:95], v[104:107], v[8:11], 0
    v_mfma_f32_32x32x16_bf16 v[80:95], v[108:111], v[12:15], v[80:95]
    v_cvt_pk_bf16_f32 v96, v32, v33
    v_cvt_pk_bf16_f32 v97, v34, v35
    v_cvt_pk_bf16_f32 v98, v36, v37
    v_cvt_pk_bf16_f32 v99, v38, v39
    v_cvt_pk_bf16_f32 v100, v40, v41
    v_cvt_pk_bf16_f32 v101, v42, v43
    v_cvt_pk_bf16_f32 v102, v44, v45
    v_cvt_pk_bf16_f32 v103, v46, v47
    v_exp_f32 v48, v48
    v_exp_f32 v49, v49
    v_exp_f32 v50, v50
    v_exp_f32 v51, v51
    v_exp_f32 v52, v52
    v_exp_f32 v53, v53
    v_exp_f32 v54, v54
    v_exp_f32 v55, v55
    s_waitcnt lgkmcnt(0)
    v_mfma_f32_32x32x16_bf16 v[16:31], v[112:115], v[96:99], v[16:31]
    v_exp_f32 v56, v56
    v_exp_f32 v57, v57
    v_exp_f32 v58, v58
    v_exp_f32 v59, v59
    v_mfma_f32_32x32x16_bf16 v[16:31], v[116:119], v[100:103], v[16:31]
    v_exp_f32 v60, v60
    v_exp_f32 v61, v61
    v_exp_f32 v62, v62
    v_exp_f32 v63, v63
    v_cvt_pk_bf16_f32 v104, v48, v49
    v_cvt_pk_bf16_f32 v105, v50, v51
    v_cvt_pk_bf16_f32 v106, v52, v53
    v_cvt_pk_bf16_f32 v107, v54, v55
    v_cvt_pk_bf16_f32 v108, v56, v57
    v_cvt_pk_bf16_f32 v109, v58, v59
    v_cvt_pk_bf16_f32 v110, v60, v61
    v_cvt_pk_bf16_f32 v111, v62, v63
    v_mfma_f32_32x32x16_bf16 v[16:31], v[120:123], v[104:107], v[16:31]
    s_nop 0
    v_mfma_f32_32x32x16_bf16 v[16:31], v[124:127], v[108:111], v[16:31]
    ds_read_b128 v[96:99], v4 offset:8192
    ds_read_b128 v[100:103], v4 offset:9216
    ds_read_b128 v[104:107], v4 offset:10240
    ds_read_b128 v[108:111], v4 offset:11264
    ds_read_b128 v[112:115], v4 offset:20480
    ds_read_b128 v[116:119], v4 offset:21504
    ds_read_b128 v[120:123], v4 offset:22528
    ds_read_b128 v[124:127], v4 offset:23552
    v_exp_f32 v64, v64
    v_exp_f32 v65, v65
    v_exp_f32 v66, v66
    v_exp_f32 v67, v67
    v_exp_f32 v68, v68
    v_exp_f32 v69, v69
    v_exp_f32 v70, v70
    v_exp_f32 v71, v71
    v_exp_f32 v72, v72
    v_exp_f32 v73, v73
    v_exp_f32 v74, v74
    v_exp_f32 v75, v75
    v_exp_f32 v76, v76
    v_exp_f32 v77, v77
    v_exp_f32 v78, v78
    v_exp_f32 v79, v79
    s_waitcnt lgkmcnt(4)
    v_mfma_f32_32x32x16_bf16 v[32:47], v[96:99], v[8:11], 0
    v_mfma_f32_32x32x16_bf16 v[32:47], v[100:103], v[12:15], v[32:47]
    v_mfma_f32_32x32x16_bf16 v[48:63], v[104:107], v[8:11], 0
    v_mfma_f32_32x32x16_bf16 v[48:63], v[108:111], v[12:15], v[48:63]
    v_cvt_pk_bf16_f32 v96, v64, v65
    v_cvt_pk_bf16_f32 v97, v66, v67
    v_cvt_pk_bf16_f32 v98, v68, v69
    v_cvt_pk_bf16_f32 v99, v70, v71
    v_cvt_pk_bf16_f32 v100, v72, v73
    v_cvt_pk_bf16_f32 v101, v74, v75
    v_cvt_pk_bf16_f32 v102, v76, v77
    v_cvt_pk_bf16_f32 v103, v78, v79
    v_exp_f32 v80, v80
    v_exp_f32 v81, v81
    v_exp_f32 v82, v82
    v_exp_f32 v83, v83
    v_exp_f32 v84, v84
    v_exp_f32 v85, v85
    v_exp_f32 v86, v86
    v_exp_f32 v87, v87
    s_waitcnt lgkmcnt(0)
    v_mfma_f32_32x32x16_bf16 v[16:31], v[112:115], v[96:99], v[16:31]
    v_exp_f32 v88, v88
    v_exp_f32 v89, v89
    v_exp_f32 v90, v90
    v_exp_f32 v91, v91
    v_mfma_f32_32x32x16_bf16 v[16:31], v[116:119], v[100:103], v[16:31]
    v_exp_f32 v92, v92
    v_exp_f32 v93, v93
    v_exp_f32 v94, v94
    v_exp_f32 v95, v95
    v_cvt_pk_bf16_f32 v104, v80, v81
    v_cvt_pk_bf16_f32 v105, v82, v83
    v_cvt_pk_bf16_f32 v106, v84, v85
    v_cvt_pk_bf16_f32 v107, v86, v87
    v_cvt_pk_bf16_f32 v108, v88, v89
    v_cvt_pk_bf16_f32 v109, v90, v91
    v_cvt_pk_bf16_f32 v110, v92, v93
    v_cvt_pk_bf16_f32 v111, v94, v95
    v_mfma_f32_32x32x16_bf16 v[16:31], v[120:123], v[104:107], v[16:31]
    s_nop 0
    v_mfma_f32_32x32x16_bf16 v[16:31], v[124:127], v[108:111], v[16:31]
    s_waitcnt vmcnt(0)
    s_barrier
    ds_read_b128 v[96:99], v4 offset:12288
    ds_read_b128 v[100:103], v4 offset:13312
    ds_read_b128 v[104:107], v4 offset:14336
    ds_read_b128 v[108:111], v4 offset:15360
    ds_read_b128 v[112:115], v4 offset:24576
    ds_read_b128 v[116:119], v4 offset:25600
    ds_read_b128 v[120:123], v4 offset:26624
    ds_read_b128 v[124:127], v4 offset:27648
    v_exp_f32 v32, v32
    v_exp_f32 v33, v33
    v_exp_f32 v34, v34
    v_exp_f32 v35, v35
    v_exp_f32 v36, v36
    v_exp_f32 v37, v37
    v_exp_f32 v38, v38
    v_exp_f32 v39, v39
    v_exp_f32 v40, v40
    v_exp_f32 v41, v41
    v_exp_f32 v42, v42
    v_exp_f32 v43, v43
    v_exp_f32 v44, v44
    v_exp_f32 v45, v45
    v_exp_f32 v46, v46
    v_exp_f32 v47, v47
    s_waitcnt lgkmcnt(4)
    v_mfma_f32_32x32x16_bf16 v[64:79], v[96:99], v[8:11], 0
    v_mfma_f32_32x32x16_bf16 v[64:79], v[100:103], v[12:15], v[64:79]
    v_mfma_f32_32x32x16_bf16 v[80:95], v[104:107], v[8:11], 0
    v_mfma_f32_32x32x16_bf16 v[80:95], v[108:111], v[12:15], v[80:95]
    v_cvt_pk_bf16_f32 v96, v32, v33
    v_cvt_pk_bf16_f32 v97, v34, v35
    v_cvt_pk_bf16_f32 v98, v36, v37
    v_cvt_pk_bf16_f32 v99, v38, v39
    v_cvt_pk_bf16_f32 v100, v40, v41
    v_cvt_pk_bf16_f32 v101, v42, v43
    v_cvt_pk_bf16_f32 v102, v44, v45
    v_cvt_pk_bf16_f32 v103, v46, v47
    v_exp_f32 v48, v48
    v_exp_f32 v49, v49
    v_exp_f32 v50, v50
    v_exp_f32 v51, v51
    v_exp_f32 v52, v52
    v_exp_f32 v53, v53
    v_exp_f32 v54, v54
    v_exp_f32 v55, v55
    s_waitcnt lgkmcnt(0)
    v_mfma_f32_32x32x16_bf16 v[16:31], v[112:115], v[96:99], v[16:31]
    v_exp_f32 v56, v56
    v_exp_f32 v57, v57
    v_exp_f32 v58, v58
    v_exp_f32 v59, v59
    v_mfma_f32_32x32x16_bf16 v[16:31], v[116:119], v[100:103], v[16:31]
    v_exp_f32 v60, v60
    v_exp_f32 v61, v61
    v_exp_f32 v62, v62
    v_exp_f32 v63, v63
    v_cvt_pk_bf16_f32 v104, v48, v49
    v_cvt_pk_bf16_f32 v105, v50, v51
    v_cvt_pk_bf16_f32 v106, v52, v53
    v_cvt_pk_bf16_f32 v107, v54, v55
    v_cvt_pk_bf16_f32 v108, v56, v57
    v_cvt_pk_bf16_f32 v109, v58, v59
    v_cvt_pk_bf16_f32 v110, v60, v61
    v_cvt_pk_bf16_f32 v111, v62, v63
    v_mfma_f32_32x32x16_bf16 v[16:31], v[120:123], v[104:107], v[16:31]
    s_nop 0
    v_mfma_f32_32x32x16_bf16 v[16:31], v[124:127], v[108:111], v[16:31]
    ds_read_b128 v[112:115], v4 offset:28672
    ds_read_b128 v[116:119], v4 offset:29696
    ds_read_b128 v[120:123], v4 offset:30720
    ds_read_b128 v[124:127], v4 offset:31744
    v_exp_f32 v64, v64
    v_exp_f32 v65, v65
    v_exp_f32 v66, v66
    v_exp_f32 v67, v67
    v_exp_f32 v68, v68
    v_exp_f32 v69, v69
    v_exp_f32 v70, v70
    v_exp_f32 v71, v71
    v_exp_f32 v72, v72
    v_exp_f32 v73, v73
    v_exp_f32 v74, v74
    v_exp_f32 v75, v75
    v_exp_f32 v76, v76
    v_exp_f32 v77, v77
    v_exp_f32 v78, v78
    v_exp_f32 v79, v79
    v_cvt_pk_bf16_f32 v96, v64, v65
    v_cvt_pk_bf16_f32 v97, v66, v67
    v_cvt_pk_bf16_f32 v98, v68, v69
    v_cvt_pk_bf16_f32 v99, v70, v71
    v_cvt_pk_bf16_f32 v100, v72, v73
    v_cvt_pk_bf16_f32 v101, v74, v75
    v_cvt_pk_bf16_f32 v102, v76, v77
    v_cvt_pk_bf16_f32 v103, v78, v79
    v_exp_f32 v80, v80
    v_exp_f32 v81, v81
    v_exp_f32 v82, v82
    v_exp_f32 v83, v83
    v_exp_f32 v84, v84
    v_exp_f32 v85, v85
    v_exp_f32 v86, v86
    v_exp_f32 v87, v87
    s_waitcnt lgkmcnt(0)
    v_mfma_f32_32x32x16_bf16 v[16:31], v[112:115], v[96:99], v[16:31]
    v_exp_f32 v88, v88
    v_exp_f32 v89, v89
    v_exp_f32 v90, v90
    v_exp_f32 v91, v91
    v_mfma_f32_32x32x16_bf16 v[16:31], v[116:119], v[100:103], v[16:31]
    v_exp_f32 v92, v92
    v_exp_f32 v93, v93
    v_exp_f32 v94, v94
    v_exp_f32 v95, v95
    v_cvt_pk_bf16_f32 v104, v80, v81
    v_cvt_pk_bf16_f32 v105, v82, v83
    v_cvt_pk_bf16_f32 v106, v84, v85
    v_cvt_pk_bf16_f32 v107, v86, v87
    v_cvt_pk_bf16_f32 v108, v88, v89
    v_cvt_pk_bf16_f32 v109, v90, v91
    v_cvt_pk_bf16_f32 v110, v92, v93
    v_cvt_pk_bf16_f32 v111, v94, v95
    v_mfma_f32_32x32x16_bf16 v[16:31], v[120:123], v[104:107], v[16:31]
    s_nop 0
    v_mfma_f32_32x32x16_bf16 v[16:31], v[124:127], v[108:111], v[16:31]
    s_waitcnt vmcnt(0)
    s_barrier
    s_mov_b32 s73, 0x207
    s_mov_b64 s[74:75], 0
    s_nop 7
    v_cmp_class_f32 vcc, v16, s73
    s_nop 3
    s_or_b64 s[74:75], s[74:75], vcc
    v_cmp_class_f32 vcc, v17, s73
    s_nop 3
    s_or_b64 s[74:75], s[74:75], vcc
    v_cmp_class_f32 vcc, v18, s73
    s_nop 3
    s_or_b64 s[74:75], s[74:75], vcc
    v_cmp_class_f32 vcc, v19, s73
    s_nop 3
    s_or_b64 s[74:75], s[74:75], vcc
    v_cmp_class_f32 vcc, v20, s73
    s_nop 3
    s_or_b64 s[74:75], s[74:75], vcc
    v_cmp_class_f32 vcc, v21, s73
    s_nop 3
    s_or_b64 s[74:75], s[74:75], vcc
    v_cmp_class_f32 vcc, v22, s73
    s_nop 3
    s_or_b64 s[74:75], s[74:75], vcc
    v_cmp_class_f32 vcc, v23, s73
    s_nop 3
    s_or_b64 s[74:75], s[74:75], vcc
    v_cmp_class_f32 vcc, v24, s73
    s_nop 3
    s_or_b64 s[74:75], s[74:75], vcc
    v_cmp_class_f32 vcc, v25, s73
    s_nop 3
    s_or_b64 s[74:75], s[74:75], vcc
    v_cmp_class_f32 vcc, v26, s73
    s_nop 3
    s_or_b64 s[74:75], s[74:75], vcc
    v_cmp_class_f32 vcc, v27, s73
    s_nop 3
    s_or_b64 s[74:75], s[74:75], vcc
    v_cmp_class_f32 vcc, v28, s73
    s_nop 3
    s_or_b64 s[74:75], s[74:75], vcc
    v_cmp_class_f32 vcc, v29, s73
    s_nop 3
    s_or_b64 s[74:75], s[74:75], vcc
    v_cmp_class_f32 vcc, v30, s73
    s_nop 3
    s_or_b64 s[74:75], s[74:75], vcc
    v_cmp_class_f32 vcc, v31, s73
    s_nop 3
    s_or_b64 s[74:75], s[74:75], vcc
    v_cmp_gt_f32 vcc, 0x2f800000, v28
    s_nop 3
    s_and_b64 vcc, vcc, s[66:67]
    s_or_b64 s[74:75], s[74:75], vcc
    s_cmp_lg_u64 s[74:75], 0
    s_cselect_b32 s76, 1, 0
    v_mov_b32 v6, s76
    v_mov_b32 v7, s6
    v_lshlrev_b32 v7, 2, v7
    v_add_u32 v7, 65536, v7
    ds_write_b32 v7, v6
    s_waitcnt lgkmcnt(0)
    s_barrier
    v_mov_b32 v7, 65536
    ds_read_b128 v[32:35], v7
    ds_read_b128 v[36:39], v7 offset:16
    s_waitcnt lgkmcnt(0)
    v_or_b32 v32, v32, v33
    v_or_b32 v34, v34, v35
    v_or_b32 v36, v36, v37
    v_or_b32 v38, v38, v39
    v_or3_b32 v32, v32, v34, v36
    v_or_b32 v32, v32, v38
    s_nop 0
    v_readfirstlane_b32 s76, v32
    s_nop 3
    s_cmp_lg_u32 s76, 0
    s_cbranch_scc1 L_attn_safe
L_attn_merge:
    s_cmp_eq_u32 s8, 0
    s_cbranch_scc1 L_attn_merge_wait
    s_mul_i32 s77, s7, 4352
    v_lshlrev_b32 v7, 2, v1
    v_add_u32 v7, s77, v7
    ds_write_b32 v7, v16 offset:0
    ds_write_b32 v7, v17 offset:256
    ds_write_b32 v7, v18 offset:512
    ds_write_b32 v7, v19 offset:768
    ds_write_b32 v7, v20 offset:1024
    ds_write_b32 v7, v21 offset:1280
    ds_write_b32 v7, v22 offset:1536
    ds_write_b32 v7, v23 offset:1792
    ds_write_b32 v7, v24 offset:2048
    ds_write_b32 v7, v25 offset:2304
    ds_write_b32 v7, v26 offset:2560
    ds_write_b32 v7, v27 offset:2816
    ds_write_b32 v7, v28 offset:3072
    ds_write_b32 v7, v29 offset:3328
    ds_write_b32 v7, v30 offset:3584
    ds_write_b32 v7, v31 offset:3840
    ds_write_b32 v7, v5 offset:4096
    s_waitcnt lgkmcnt(0)
    s_barrier
    s_endpgm
L_attn_merge_wait:
    s_barrier
    s_mul_i32 s77, s7, 4352
    v_lshlrev_b32 v7, 2, v1
    v_add_u32 v7, s77, v7
    ds_read_b32 v32, v7 offset:0
    ds_read_b32 v33, v7 offset:256
    ds_read_b32 v34, v7 offset:512
    ds_read_b32 v35, v7 offset:768
    ds_read_b32 v36, v7 offset:1024
    ds_read_b32 v37, v7 offset:1280
    ds_read_b32 v38, v7 offset:1536
    ds_read_b32 v39, v7 offset:1792
    ds_read_b32 v40, v7 offset:2048
    ds_read_b32 v41, v7 offset:2304
    ds_read_b32 v42, v7 offset:2560
    ds_read_b32 v43, v7 offset:2816
    ds_read_b32 v44, v7 offset:3072
    ds_read_b32 v45, v7 offset:3328
    ds_read_b32 v46, v7 offset:3584
    ds_read_b32 v47, v7 offset:3840
    ds_read_b32 v48, v7 offset:4096
    s_waitcnt lgkmcnt(0)
    v_max_f32 v6, v5, v48
    v_sub_f32 v7, v5, v6
    v_sub_f32 v2, v48, v6
    v_exp_f32 v7, v7
    v_exp_f32 v2, v2
    v_mul_f32 v16, v16, v7
    v_mul_f32 v17, v17, v7
    v_mul_f32 v18, v18, v7
    v_mul_f32 v19, v19, v7
    v_mul_f32 v20, v20, v7
    v_mul_f32 v21, v21, v7
    v_mul_f32 v22, v22, v7
    v_mul_f32 v23, v23, v7
    v_mul_f32 v24, v24, v7
    v_mul_f32 v25, v25, v7
    v_mul_f32 v26, v26, v7
    v_mul_f32 v27, v27, v7
    v_mul_f32 v28, v28, v7
    v_mul_f32 v29, v29, v7
    v_mul_f32 v30, v30, v7
    v_mul_f32 v31, v31, v7
    v_fma_f32 v16, v32, v2, v16
    v_fma_f32 v17, v33, v2, v17
    v_fma_f32 v18, v34, v2, v18
    v_fma_f32 v19, v35, v2, v19
    v_fma_f32 v20, v36, v2, v20
    v_fma_f32 v21, v37, v2, v21
    v_fma_f32 v22, v38, v2, v22
    v_fma_f32 v23, v39, v2, v23
    v_fma_f32 v24, v40, v2, v24
    v_fma_f32 v25, v41, v2, v25
    v_fma_f32 v26, v42, v2, v26
    v_fma_f32 v27, v43, v2, v27
    v_fma_f32 v28, v44, v2, v28
    v_fma_f32 v29, v45, v2, v29
    v_fma_f32 v30, v46, v2, v30
    v_fma_f32 v31, v47, v2, v31
    v_mov_b32 v6, v28
    v_mov_b32 v7, v28
    s_nop 1
    v_permlane32_swap_b32 v6, v7
    v_rcp_f32 v7, v7
    s_nop 0
    v_mul_f32 v16, v16, v7
    v_mul_f32 v17, v17, v7
    v_mul_f32 v18, v18, v7
    v_mul_f32 v19, v19, v7
    v_mul_f32 v20, v20, v7
    v_mul_f32 v21, v21, v7
    v_mul_f32 v22, v22, v7
    v_mul_f32 v23, v23, v7
    v_mul_f32 v24, v24, v7
    v_mul_f32 v25, v25, v7
    v_mul_f32 v26, v26, v7
    v_mul_f32 v27, v27, v7
    v_mul_f32 v28, v28, v7
    v_mul_f32 v29, v29, v7
    v_mul_f32 v30, v30, v7
    v_mul_f32 v31, v31, v7
    v_cvt_pk_bf16_f32 v16, v16, v17
    v_cvt_pk_bf16_f32 v17, v18, v19
    v_cvt_pk_bf16_f32 v18, v20, v21
    v_cvt_pk_bf16_f32 v19, v22, v23
    v_cvt_pk_bf16_f32 v20, v24, v25
    v_cvt_pk_bf16_f32 v21, v26, v27
    v_cvt_pk_bf16_f32 v22, v28, v29
    v_cvt_pk_bf16_f32 v23, v30, v31
    s_lshl_b32 s77, s9, 5
    s_lshl_b32 s78, s4, 1
    s_add_u32 s77, s77, s78
    s_lshl_b32 s77, s77, 10
    s_add_u32 s77, s77, 12582912
    buffer_store_dwordx4 v[16:19], v3, s[56:59], s77 offen
    buffer_store_dwordx4 v[20:23], v3, s[56:59], s77 offen offset:1024
    s_endpgm
L_attn_safe:
    s_mov_b32 s70, s14
    s_mov_b32 s71, s15
    s_add_u32 s69, s61, 0
    s_mov_b32 m0, s69
    s_nop 0
    buffer_load_dwordx4 v3, s[56:59], s70 offen lds
    s_add_u32 s69, s61, 16384
    s_mov_b32 m0, s69
    s_nop 0
    buffer_load_dwordx4 v3, s[56:59], s71 offen lds
    v_mov_b32 v16, 0
    v_mov_b32 v17, 0
    v_mov_b32 v18, 0
    v_mov_b32 v19, 0
    v_mov_b32 v20, 0
    v_mov_b32 v21, 0
    v_mov_b32 v22, 0
    v_mov_b32 v23, 0
    v_mov_b32 v24, 0
    v_mov_b32 v25, 0
    v_mov_b32 v26, 0
    v_mov_b32 v27, 0
    v_mov_b32 v28, 0
    v_mov_b32 v29, 0
    v_mov_b32 v30, 0
    v_mov_b32 v31, 0
    v_mov_b32 v5, 0xff800000
    s_mov_b64 exec, s[66:67]
    v_mov_b32 v14, 0
    s_mov_b64 exec, -1
    s_waitcnt vmcnt(0)
    s_barrier
    s_mov_b32 s72, 8
L_attn_loop_safe:
    ds_read_b128 v[96:99], v4 offset:0
    ds_read_b128 v[100:103], v4 offset:1024
    ds_read_b128 v[104:107], v4 offset:2048
    ds_read_b128 v[108:111], v4 offset:3072
    s_add_u32 s70, s70, 4096
    s_add_u32 s71, s71, 4096
    s_add_u32 s69, s61, 4096
    s_mov_b32 m0, s69
    s_nop 0
    buffer_load_dwordx4 v3, s[56:59], s70 offen lds
    s_add_u32 s69, s61, 20480
    s_mov_b32 m0, s69
    s_nop 0
    buffer_load_dwordx4 v3, s[56:59], s71 offen lds
    ds_read_b128 v[112:115], v4 offset:16384
    ds_read_b128 v[116:119], v4 offset:17408
    ds_read_b128 v[120:123], v4 offset:18432
    ds_read_b128 v[124:127], v4 offset:19456
    s_waitcnt lgkmcnt(4)
    v_mfma_f32_32x32x16_bf16 v[32:47], v[96:99], v[8:11], 0
    v_mfma_f32_32x32x16_bf16 v[32:47], v[100:103], v[12:15], v[32:47]
    v_mfma_f32_32x32x16_bf16 v[48:63], v[104:107], v[8:11], 0
    v_mfma_f32_32x32x16_bf16 v[48:63], v[108:111], v[12:15], v[48:63]
    s_nop 9
    v_max3_f32 v6, v32, v33, v34
    v_max3_f32 v6, v6, v35, v36
    v_max3_f32 v6, v6, v37, v38
    v_max3_f32 v6, v6, v39, v40
    v_max3_f32 v6, v6, v41, v42
    v_max3_f32 v6, v6, v43, v44
    v_max3_f32 v6, v6, v45, v46
    v_max3_f32 v6, v6, v47, v48
    v_max3_f32 v6, v6, v49, v50
    v_max3_f32 v6, v6, v51, v52
    v_max3_f32 v6, v6, v53, v54
    v_max3_f32 v6, v6, v55, v56
    v_max3_f32 v6, v6, v57, v58
    v_max3_f32 v6, v6, v59, v60
    v_max3_f32 v6, v6, v61, v62
    v_max_f32 v6, v6, v63
    v_mov_b32 v7, v6
    s_nop 1
    v_permlane32_swap_b32 v6, v7
    v_max_f32 v6, v6, v7
    v_max_f32 v6, v6, v5
    v_sub_f32 v2, v5, v6
    v_exp_f32 v2, v2
    v_mov_b32 v5, v6
    v_mul_f32 v16, v16, v2
    v_mul_f32 v17, v17, v2
    v_mul_f32 v18, v18, v2
    v_mul_f32 v19, v19, v2
    v_mul_f32 v20, v20, v2
    v_mul_f32 v21, v21, v2
    v_mul_f32 v22, v22, v2
    v_mul_f32 v23, v23, v2
    v_mul_f32 v24, v24, v2
    v_mul_f32 v25, v25, v2
    v_mul_f32 v26, v26, v2
    v_mul_f32 v27, v27, v2
    v_mul_f32 v28, v28, v2
    v_mul_f32 v29, v29, v2
    v_mul_f32 v30, v30, v2
    v_mul_f32 v31, v31, v2
    v_sub_f32 v32, v32, v6
    v_sub_f32 v33, v33, v6
    v_sub_f32 v34, v34, v6
    v_sub_f32 v35, v35, v6
    v_sub_f32 v36, v36, v6
    v_sub_f32 v37, v37, v6
    v_sub_f32 v38, v38, v6
    v_sub_f32 v39, v39, v6
    v_sub_f32 v40, v40, v6
    v_sub_f32 v41, v41, v6
    v_sub_f32 v42, v42, v6
    v_sub_f32 v43, v43, v6
    v_sub_f32 v44, v44, v6
    v_sub_f32 v45, v45, v6
    v_sub_f32 v46, v46, v6
    v_sub_f32 v47, v47, v6
    v_sub_f32 v48, v48, v6
    v_sub_f32 v49, v49, v6
    v_sub_f32 v50, v50, v6
    v_sub_f32 v51, v51, v6
    v_sub_f32 v52, v52, v6
    v_sub_f32 v53, v53, v6
    v_sub_f32 v54, v54, v6
    v_sub_f32 v55, v55, v6
    v_sub_f32 v56, v56, v6
    v_sub_f32 v57, v57, v6
    v_sub_f32 v58, v58, v6
    v_sub_f32 v59, v59, v6
    v_sub_f32 v60, v60, v6
    v_sub_f32 v61, v61, v6
    v_sub_f32 v62, v62, v6
    v_sub_f32 v63, v63, v6
    v_exp_f32 v32, v32
    v_exp_f32 v33, v33
    v_exp_f32 v34, v34
    v_exp_f32 v35, v35
    v_exp_f32 v36, v36
    v_exp_f32 v37, v37
    v_exp_f32 v38, v38
    v_exp_f32 v39, v39
    v_exp_f32 v40, v40
    v_exp_f32 v41, v41
    v_exp_f32 v42, v42
    v_exp_f32 v43, v43
    v_exp_f32 v44, v44
    v_exp_f32 v45, v45
    v_exp_f32 v46, v46
    v_exp_f32 v47, v47
    v_exp_f32 v48, v48
    v_exp_f32 v49, v49
    v_exp_f32 v50, v50
    v_exp_f32 v51, v51
    v_exp_f32 v52, v52
    v_exp_f32 v53, v53
    v_exp_f32 v54, v54
    v_exp_f32 v55, v55
    v_exp_f32 v56, v56
    v_exp_f32 v57, v57
    v_exp_f32 v58, v58
    v_exp_f32 v59, v59
    v_exp_f32 v60, v60
    v_exp_f32 v61, v61
    v_exp_f32 v62, v62
    v_exp_f32 v63, v63
    v_cvt_pk_bf16_f32 v64, v32, v33
    v_cvt_pk_bf16_f32 v65, v34, v35
    v_cvt_pk_bf16_f32 v66, v36, v37
    v_cvt_pk_bf16_f32 v67, v38, v39
    v_cvt_pk_bf16_f32 v68, v40, v41
    v_cvt_pk_bf16_f32 v69, v42, v43
    v_cvt_pk_bf16_f32 v70, v44, v45
    v_cvt_pk_bf16_f32 v71, v46, v47
    v_cvt_pk_bf16_f32 v72, v48, v49
    v_cvt_pk_bf16_f32 v73, v50, v51
    v_cvt_pk_bf16_f32 v74, v52, v53
    v_cvt_pk_bf16_f32 v75, v54, v55
    v_cvt_pk_bf16_f32 v76, v56, v57
    v_cvt_pk_bf16_f32 v77, v58, v59
    v_cvt_pk_bf16_f32 v78, v60, v61
    v_cvt_pk_bf16_f32 v79, v62, v63
    s_waitcnt lgkmcnt(0)
    v_mfma_f32_32x32x16_bf16 v[16:31], v[112:115], v[64:67], v[16:31]
    v_mfma_f32_32x32x16_bf16 v[16:31], v[116:119], v[68:71], v[16:31]
    v_mfma_f32_32x32x16_bf16 v[16:31], v[120:123], v[72:75], v[16:31]
    v_mfma_f32_32x32x16_bf16 v[16:31], v[124:127], v[76:79], v[16:31]
    s_waitcnt vmcnt(0)
    s_barrier
    ds_read_b128 v[96:99], v4 offset:4096
    ds_read_b128 v[100:103], v4 offset:5120
    ds_read_b128 v[104:107], v4 offset:6144
    ds_read_b128 v[108:111], v4 offset:7168
    s_add_u32 s70, s70, 4096
    s_add_u32 s71, s71, 4096
    s_add_u32 s69, s61, 0
    s_mov_b32 m0, s69
    s_nop 0
    buffer_load_dwordx4 v3, s[56:59], s70 offen lds
    s_add_u32 s69, s61, 16384
    s_mov_b32 m0, s69
    s_nop 0
    buffer_load_dwordx4 v3, s[56:59], s71 offen lds
    ds_read_b128 v[112:115], v4 offset:20480
    ds_read_b128 v[116:119], v4 offset:21504
    ds_read_b128 v[120:123], v4 offset:22528
    ds_read_b128 v[124:127], v4 offset:23552
    s_waitcnt lgkmcnt(4)
    v_mfma_f32_32x32x16_bf16 v[32:47], v[96:99], v[8:11], 0
    v_mfma_f32_32x32x16_bf16 v[32:47], v[100:103], v[12:15], v[32:47]
    v_mfma_f32_32x32x16_bf16 v[48:63], v[104:107], v[8:11], 0
    v_mfma_f32_32x32x16_bf16 v[48:63], v[108:111], v[12:15], v[48:63]
    s_nop 9
    v_max3_f32 v6, v32, v33, v34
    v_max3_f32 v6, v6, v35, v36
    v_max3_f32 v6, v6, v37, v38
    v_max3_f32 v6, v6, v39, v40
    v_max3_f32 v6, v6, v41, v42
    v_max3_f32 v6, v6, v43, v44
    v_max3_f32 v6, v6, v45, v46
    v_max3_f32 v6, v6, v47, v48
    v_max3_f32 v6, v6, v49, v50
    v_max3_f32 v6, v6, v51, v52
    v_max3_f32 v6, v6, v53, v54
    v_max3_f32 v6, v6, v55, v56
    v_max3_f32 v6, v6, v57, v58
    v_max3_f32 v6, v6, v59, v60
    v_max3_f32 v6, v6, v61, v62
    v_max_f32 v6, v6, v63
    v_mov_b32 v7, v6
    s_nop 1
    v_permlane32_swap_b32 v6, v7
    v_max_f32 v6, v6, v7
    v_max_f32 v6, v6, v5
    v_sub_f32 v2, v5, v6
    v_exp_f32 v2, v2
    v_mov_b32 v5, v6
    v_mul_f32 v16, v16, v2
    v_mul_f32 v17, v17, v2
    v_mul_f32 v18, v18, v2
    v_mul_f32 v19, v19, v2
    v_mul_f32 v20, v20, v2
    v_mul_f32 v21, v21, v2
    v_mul_f32 v22, v22, v2
    v_mul_f32 v23, v23, v2
    v_mul_f32 v24, v24, v2
    v_mul_f32 v25, v25, v2
    v_mul_f32 v26, v26, v2
    v_mul_f32 v27, v27, v2
    v_mul_f32 v28, v28, v2
    v_mul_f32 v29, v29, v2
    v_mul_f32 v30, v30, v2
    v_mul_f32 v31, v31, v2
    v_sub_f32 v32, v32, v6
    v_sub_f32 v33, v33, v6
    v_sub_f32 v34, v34, v6
    v_sub_f32 v35, v35, v6
    v_sub_f32 v36, v36, v6
    v_sub_f32 v37, v37, v6
    v_sub_f32 v38, v38, v6
    v_sub_f32 v39, v39, v6
    v_sub_f32 v40, v40, v6
    v_sub_f32 v41, v41, v6
    v_sub_f32 v42, v42, v6
    v_sub_f32 v43, v43, v6
    v_sub_f32 v44, v44, v6
    v_sub_f32 v45, v45, v6
    v_sub_f32 v46, v46, v6
    v_sub_f32 v47, v47, v6
    v_sub_f32 v48, v48, v6
    v_sub_f32 v49, v49, v6
    v_sub_f32 v50, v50, v6
    v_sub_f32 v51, v51, v6
    v_sub_f32 v52, v52, v6
    v_sub_f32 v53, v53, v6
    v_sub_f32 v54, v54, v6
    v_sub_f32 v55, v55, v6
    v_sub_f32 v56, v56, v6
    v_sub_f32 v57, v57, v6
    v_sub_f32 v58, v58, v6
    v_sub_f32 v59, v59, v6
    v_sub_f32 v60, v60, v6
    v_sub_f32 v61, v61, v6
    v_sub_f32 v62, v62, v6
    v_sub_f32 v63, v63, v6
    v_exp_f32 v32, v32
    v_exp_f32 v33, v33
    v_exp_f32 v34, v34
    v_exp_f32 v35, v35
    v_exp_f32 v36, v36
    v_exp_f32 v37, v37
    v_exp_f32 v38, v38
    v_exp_f32 v39, v39
    v_exp_f32 v40, v40
    v_exp_f32 v41, v41
    v_exp_f32 v42, v42
    v_exp_f32 v43, v43
    v_exp_f32 v44, v44
    v_exp_f32 v45, v45
    v_exp_f32 v46, v46
    v_exp_f32 v47, v47
    v_exp_f32 v48, v48
    v_exp_f32 v49, v49
    v_exp_f32 v50, v50
    v_exp_f32 v51, v51
    v_exp_f32 v52, v52
    v_exp_f32 v53, v53
    v_exp_f32 v54, v54
    v_exp_f32 v55, v55
    v_exp_f32 v56, v56
    v_exp_f32 v57, v57
    v_exp_f32 v58, v58
    v_exp_f32 v59, v59
    v_exp_f32 v60, v60
    v_exp_f32 v61, v61
    v_exp_f32 v62, v62
    v_exp_f32 v63, v63
    v_cvt_pk_bf16_f32 v64, v32, v33
    v_cvt_pk_bf16_f32 v65, v34, v35
    v_cvt_pk_bf16_f32 v66, v36, v37
    v_cvt_pk_bf16_f32 v67, v38, v39
    v_cvt_pk_bf16_f32 v68, v40, v41
    v_cvt_pk_bf16_f32 v69, v42, v43
    v_cvt_pk_bf16_f32 v70, v44, v45
    v_cvt_pk_bf16_f32 v71, v46, v47
    v_cvt_pk_bf16_f32 v72, v48, v49
    v_cvt_pk_bf16_f32 v73, v50, v51
    v_cvt_pk_bf16_f32 v74, v52, v53
    v_cvt_pk_bf16_f32 v75, v54, v55
    v_cvt_pk_bf16_f32 v76, v56, v57
    v_cvt_pk_bf16_f32 v77, v58, v59
    v_cvt_pk_bf16_f32 v78, v60, v61
    v_cvt_pk_bf16_f32 v79, v62, v63
    s_waitcnt lgkmcnt(0)
    v_mfma_f32_32x32x16_bf16 v[16:31], v[112:115], v[64:67], v[16:31]
    v_mfma_f32_32x32x16_bf16 v[16:31], v[116:119], v[68:71], v[16:31]
    v_mfma_f32_32x32x16_bf16 v[16:31], v[120:123], v[72:75], v[16:31]
    v_mfma_f32_32x32x16_bf16 v[16:31], v[124:127], v[76:79], v[16:31]
    s_waitcnt vmcnt(0)
    s_barrier
    s_sub_u32 s72, s72, 1
    s_cmp_lg_u32 s72, 0
    s_cbranch_scc1 L_attn_loop_safe
    s_branch L_attn_merge
L_attn_mod:
    v_cmp_gt_u32 vcc, 256, v0
    s_nop 4
    s_cbranch_vccz L_attn_modx
    s_cmp_ge_u32 s2, 368
    s_cbranch_scc1 L_mod_end
    s_load_dwordx16 s[16:31], s[0:1], 0
    s_load_dwordx4 s[32:35], s[0:1], 64
    s_load_dwordx2 s[36:37], s[0:1], 80
    s_sub_u32 s4, s2, 256
    v_and_b32 v1, 63, v0
    v_lshrrev_b32 v2, 6, v0
    v_lshlrev_b32 v3, 5, v0
    v_and_b32 v20, 1, v0
    v_lshrrev_b32 v21, 1, v0
    v_mul_u32_u24 v22, 3584, v21
    v_lshlrev_b32 v23, 4, v20
    v_add_u32 v22, v22, v23
    s_mov_b32 s10, 0x4924925
    v_mul_hi_u32 v36, v0, s10
    v_mul_u32_u24 v37, 56, v36
    v_sub_u32 v37, v0, v37
    v_mul_u32_u24 v38, 3584, v36
    v_lshlrev_b32 v39, 4, v37
    v_add_u32 v38, v38, v39
    v_mov_b32 v4, 0
    v_mov_b32 v5, 0
    v_lshlrev_b32 v6, 3, v0
    ds_write_b64 v6, v[4:5] offset:0
    s_waitcnt lgkmcnt(0)
    s_mov_b32 s56, s36
    s_and_b32 s57, s37, 0xffff
    s_mov_b32 s58, 16777216
    s_mov_b32 s59, 0x00020000
    s_mov_b32 s40, s26
    s_and_b32 s41, s27, 0xffff
    s_mov_b32 s42, 1605632
    s_mov_b32 s43, 0x00020000
    s_mov_b32 s44, s28
    s_and_b32 s45, s29, 0xffff
    s_mov_b32 s46, 1605632
    s_mov_b32 s47, 0x00020000
    s_mov_b32 s48, s30
    s_and_b32 s49, s31, 0xffff
    s_mov_b32 s50, 1605632
    s_mov_b32 s51, 0x00020000
    s_mov_b32 s5, 4227072
    buffer_load_dwordx4 v[8:11], v3, s[56:59], s5 offen
    buffer_load_dwordx4 v[4:7], v3, s[56:59], s5 offen offset:16
    s_lshl_b32 s5, s4, 5
    s_mul_i32 s11, s4, 14336
    s_add_u32 s8, s5, 0
    buffer_load_dwordx4 v[40:43], v22, s[40:43], s8 offen
    buffer_load_dwordx4 v[44:47], v22, s[44:47], s8 offen
    s_add_u32 s8, s5, 458752
    buffer_load_dwordx4 v[48:51], v22, s[40:43], s8 offen
    buffer_load_dwordx4 v[52:55], v22, s[44:47], s8 offen
    s_add_u32 s8, s5, 917504
    buffer_load_dwordx4 v[56:59], v22, s[40:43], s8 offen
    buffer_load_dwordx4 v[60:63], v22, s[44:47], s8 offen
    s_add_u32 s8, s5, 1376256
    buffer_load_dwordx4 v[64:67], v22, s[40:43], s8 offen
    buffer_load_dwordx4 v[68:71], v22, s[44:47], s8 offen
    s_add_u32 s8, s11, 0
    buffer_load_dwordx4 v[72:75], v38, s[48:51], s8 offen
    s_add_u32 s8, s11, 896
    buffer_load_dwordx4 v[76:79], v38, s[48:51], s8 offen
    s_add_u32 s8, s11, 1792
    buffer_load_dwordx4 v[80:83], v38, s[48:51], s8 offen
    s_add_u32 s8, s11, 2688
    buffer_load_dwordx4 v[84:87], v38, s[48:51], s8 offen
    v_lshlrev_b32 v12, 3, v0
    s_waitcnt vmcnt(12)
    v_mov_b32 v16, v8
    v_mov_b32 v17, v12
    v_add_u32 v13, 1, v12
    v_cmp_gt_f32 vcc, v9, v16
    s_nop 1
    v_cndmask_b32 v16, v16, v9, vcc
    v_cndmask_b32 v17, v17, v13, vcc
    v_add_u32 v13, 2, v12
    v_cmp_gt_f32 vcc, v10, v16
    s_nop 1
    v_cndmask_b32 v16, v16, v10, vcc
    v_cndmask_b32 v17, v17, v13, vcc
    v_add_u32 v13, 3, v12
    v_cmp_gt_f32 vcc, v11, v16
    s_nop 1
    v_cndmask_b32 v16, v16, v11, vcc
    v_cndmask_b32 v17, v17, v13, vcc
    v_add_u32 v13, 4, v12
    v_cmp_gt_f32 vcc, v4, v16
    s_nop 1
    v_cndmask_b32 v16, v16, v4, vcc
    v_cndmask_b32 v17, v17, v13, vcc
    v_add_u32 v13, 5, v12
    v_cmp_gt_f32 vcc, v5, v16
    s_nop 1
    v_cndmask_b32 v16, v16, v5, vcc
    v_cndmask_b32 v17, v17, v13, vcc
    v_add_u32 v13, 6, v12
    v_cmp_gt_f32 vcc, v6, v16
    s_nop 1
    v_cndmask_b32 v16, v16, v6, vcc
    v_cndmask_b32 v17, v17, v13, vcc
    v_add_u32 v13, 7, v12
    v_cmp_gt_f32 vcc, v7, v16
    s_nop 1
    v_cndmask_b32 v16, v16, v7, vcc
    v_cndmask_b32 v17, v17, v13, vcc
    v_xor_b32 v13, 1, v1
    v_lshlrev_b32 v13, 2, v13
    ds_bpermute_b32 v18, v13, v16
    ds_bpermute_b32 v19, v13, v17
    s_waitcnt lgkmcnt(0)
    v_cmp_gt_f32 vcc, v18, v16
    v_cmp_eq_f32 s[6:7], v18, v16
    v_cmp_lt_u32 s[8:9], v19, v17
    s_nop 3
    s_and_b64 s[6:7], s[6:7], s[8:9]
    s_or_b64 vcc, vcc, s[6:7]
    v_cndmask_b32 v16, v16, v18, vcc
    v_cndmask_b32 v17, v17, v19, vcc
    v_xor_b32 v13, 2, v1
    v_lshlrev_b32 v13, 2, v13
    ds_bpermute_b32 v18, v13, v16
    ds_bpermute_b32 v19, v13, v17
    s_waitcnt lgkmcnt(0)
    v_cmp_gt_f32 vcc, v18, v16
    v_cmp_eq_f32 s[6:7], v18, v16
    v_cmp_lt_u32 s[8:9], v19, v17
    s_nop 3
    s_and_b64 s[6:7], s[6:7], s[8:9]
    s_or_b64 vcc, vcc, s[6:7]
    v_cndmask_b32 v16, v16, v18, vcc
    v_cndmask_b32 v17, v17, v19, vcc
    v_xor_b32 v13, 4, v1
    v_lshlrev_b32 v13, 2, v13
    ds_bpermute_b32 v18, v13, v16
    ds_bpermute_b32 v19, v13, v17
    s_waitcnt lgkmcnt(0)
    v_cmp_gt_f32 vcc, v18, v16
    v_cmp_eq_f32 s[6:7], v18, v16
    v_cmp_lt_u32 s[8:9], v19, v17
    s_nop 3
    s_and_b64 s[6:7], s[6:7], s[8:9]
    s_or_b64 vcc, vcc, s[6:7]
    v_cndmask_b32 v16, v16, v18, vcc
    v_cndmask_b32 v17, v17, v19, vcc
    v_xor_b32 v13, 8, v1
    v_lshlrev_b32 v13, 2, v13
    ds_bpermute_b32 v18, v13, v16
    ds_bpermute_b32 v19, v13, v17
    s_waitcnt lgkmcnt(0)
    v_cmp_gt_f32 vcc, v18, v16
    v_cmp_eq_f32 s[6:7], v18, v16
    v_cmp_lt_u32 s[8:9], v19, v17
    s_nop 3
    s_and_b64 s[6:7], s[6:7], s[8:9]
    s_or_b64 vcc, vcc, s[6:7]
    v_cndmask_b32 v16, v16, v18, vcc
    v_cndmask_b32 v17, v17, v19, vcc
    v_xor_b32 v13, 16, v1
    v_lshlrev_b32 v13, 2, v13
    ds_bpermute_b32 v18, v13, v16
    ds_bpermute_b32 v19, v13, v17
    s_waitcnt lgkmcnt(0)
    v_cmp_gt_f32 vcc, v18, v16
    v_cmp_eq_f32 s[6:7], v18, v16
    v_cmp_lt_u32 s[8:9], v19, v17
    s_nop 3
    s_and_b64 s[6:7], s[6:7], s[8:9]
    s_or_b64 vcc, vcc, s[6:7]
    v_cndmask_b32 v16, v16, v18, vcc
    v_cndmask_b32 v17, v17, v19, vcc
    v_xor_b32 v13, 32, v1
    v_lshlrev_b32 v13, 2, v13
    ds_bpermute_b32 v18, v13, v16
    ds_bpermute_b32 v19, v13, v17
    s_waitcnt lgkmcnt(0)
    v_cmp_gt_f32 vcc, v18, v16
    v_cmp_eq_f32 s[6:7], v18, v16
    v_cmp_lt_u32 s[8:9], v19, v17
    s_nop 3
    s_and_b64 s[6:7], s[6:7], s[8:9]
    s_or_b64 vcc, vcc, s[6:7]
    v_cndmask_b32 v16, v16, v18, vcc
    v_cndmask_b32 v17, v17, v19, vcc
    v_lshlrev_b32 v13, 3, v2
    ds_write_b64 v13, v[16:17] offset:18688
    s_waitcnt lgkmcnt(0)
    s_barrier
    v_mov_b32 v13, 0
    ds_read_b128 v[24:27], v13 offset:18688
    ds_read_b128 v[28:31], v13 offset:18704
    s_waitcnt lgkmcnt(0)
    v_cmp_gt_f32 vcc, v24, v16
    v_cmp_eq_f32 s[6:7], v24, v16
    v_cmp_lt_u32 s[8:9], v25, v17
    s_nop 3
    s_and_b64 s[6:7], s[6:7], s[8:9]
    s_or_b64 vcc, vcc, s[6:7]
    v_cndmask_b32 v16, v16, v24, vcc
    v_cndmask_b32 v17, v17, v25, vcc
    v_cmp_gt_f32 vcc, v26, v16
    v_cmp_eq_f32 s[6:7], v26, v16
    v_cmp_lt_u32 s[8:9], v27, v17
    s_nop 3
    s_and_b64 s[6:7], s[6:7], s[8:9]
    s_or_b64 vcc, vcc, s[6:7]
    v_cndmask_b32 v16, v16, v26, vcc
    v_cndmask_b32 v17, v17, v27, vcc
    v_cmp_gt_f32 vcc, v28, v16
    v_cmp_eq_f32 s[6:7], v28, v16
    v_cmp_lt_u32 s[8:9], v29, v17
    s_nop 3
    s_and_b64 s[6:7], s[6:7], s[8:9]
    s_or_b64 vcc, vcc, s[6:7]
    v_cndmask_b32 v16, v16, v28, vcc
    v_cndmask_b32 v17, v17, v29, vcc
    v_cmp_gt_f32 vcc, v30, v16
    v_cmp_eq_f32 s[6:7], v30, v16
    v_cmp_lt_u32 s[8:9], v31, v17
    s_nop 3
    s_and_b64 s[6:7], s[6:7], s[8:9]
    s_or_b64 vcc, vcc, s[6:7]
    v_cndmask_b32 v16, v16, v30, vcc
    v_cndmask_b32 v17, v17, v31, vcc
    v_lshrrev_b32 v24, 5, v17
    v_and_b32 v25, 31, v17
    v_mul_u32_u24 v24, 28, v24
    v_lshrrev_b32 v26, 1, v0
    v_add_u32 v24, v24, v26
    v_lshlrev_b32 v24, 10, v24
    v_and_b32 v26, 1, v0
    v_lshlrev_b32 v26, 5, v26
    v_add_u32 v26, v26, v25
    v_lshlrev_b32 v26, 4, v26
    v_add_u32 v24, v24, v26
    v_cmp_gt_u32 vcc, 56, v0
    s_nop 3
    s_and_saveexec_b64 s[6:7], vcc
    s_mov_b32 s5, 0
    buffer_load_dwordx4 v[4:7], v24, s[56:59], s5 offen
    v_lshlrev_b32 v25, 5, v0
    s_waitcnt vmcnt(0)
    v_lshlrev_b32 v28, 16, v4
    v_and_b32 v29, 0xffff0000, v4
    v_lshlrev_b32 v30, 16, v5
    v_and_b32 v31, 0xffff0000, v5
    v_lshlrev_b32 v32, 16, v6
    v_and_b32 v33, 0xffff0000, v6
    v_lshlrev_b32 v34, 16, v7
    v_and_b32 v35, 0xffff0000, v7
    ds_write_b128 v25, v[28:31] offset:0
    ds_write_b128 v25, v[32:35] offset:16
    s_mov_b64 exec, s[6:7]
    s_waitcnt lgkmcnt(0)
    s_barrier
    v_lshlrev_b32 v23, 2, v21
    v_mov_b32 v88, 0
    v_mov_b32 v89, 0
    v_mov_b32 v90, 0
    v_mov_b32 v91, 0
    v_mov_b32 v92, 0
    v_mov_b32 v93, 0
    v_mov_b32 v94, 0
    v_mov_b32 v95, 0
    v_mov_b32 v96, 0
    v_mov_b32 v97, 0
    v_mov_b32 v98, 0
    v_mov_b32 v99, 0
    v_mov_b32 v100, 0
    v_mov_b32 v101, 0
    v_mov_b32 v102, 0
    v_mov_b32 v103, 0
    ds_read_b32 v24, v23 offset:0
    ds_read_b32 v25, v23 offset:512
    ds_read_b32 v26, v23 offset:1024
    ds_read_b32 v27, v23 offset:1536
    s_waitcnt vmcnt(0) lgkmcnt(0)
    v_lshlrev_b32 v112, 16, v40
    v_and_b32 v113, 0xffff0000, v40
    v_fma_f32 v88, v112, v24, v88
    v_fma_f32 v89, v113, v24, v89
    v_lshlrev_b32 v112, 16, v41
    v_and_b32 v113, 0xffff0000, v41
    v_fma_f32 v90, v112, v24, v90
    v_fma_f32 v91, v113, v24, v91
    v_lshlrev_b32 v112, 16, v42
    v_and_b32 v113, 0xffff0000, v42
    v_fma_f32 v92, v112, v24, v92
    v_fma_f32 v93, v113, v24, v93
    v_lshlrev_b32 v112, 16, v43
    v_and_b32 v113, 0xffff0000, v43
    v_fma_f32 v94, v112, v24, v94
    v_fma_f32 v95, v113, v24, v95
    v_lshlrev_b32 v112, 16, v44
    v_and_b32 v113, 0xffff0000, v44
    v_fma_f32 v96, v112, v24, v96
    v_fma_f32 v97, v113, v24, v97
    v_lshlrev_b32 v112, 16, v45
    v_and_b32 v113, 0xffff0000, v45
    v_fma_f32 v98, v112, v24, v98
    v_fma_f32 v99, v113, v24, v99
    v_lshlrev_b32 v112, 16, v46
    v_and_b32 v113, 0xffff0000, v46
    v_fma_f32 v100, v112, v24, v100
    v_fma_f32 v101, v113, v24, v101
    v_lshlrev_b32 v112, 16, v47
    v_and_b32 v113, 0xffff0000, v47
    v_fma_f32 v102, v112, v24, v102
    v_fma_f32 v103, v113, v24, v103
    v_lshlrev_b32 v112, 16, v48
    v_and_b32 v113, 0xffff0000, v48
    v_fma_f32 v88, v112, v25, v88
    v_fma_f32 v89, v113, v25, v89
    v_lshlrev_b32 v112, 16, v49
    v_and_b32 v113, 0xffff0000, v49
    v_fma_f32 v90, v112, v25, v90
    v_fma_f32 v91, v113, v25, v91
    v_lshlrev_b32 v112, 16, v50
    v_and_b32 v113, 0xffff0000, v50
    v_fma_f32 v92, v112, v25, v92
    v_fma_f32 v93, v113, v25, v93
    v_lshlrev_b32 v112, 16, v51
    v_and_b32 v113, 0xffff0000, v51
    v_fma_f32 v94, v112, v25, v94
    v_fma_f32 v95, v113, v25, v95
    v_lshlrev_b32 v112, 16, v52
    v_and_b32 v113, 0xffff0000, v52
    v_fma_f32 v96, v112, v25, v96
    v_fma_f32 v97, v113, v25, v97
    v_lshlrev_b32 v112, 16, v53
    v_and_b32 v113, 0xffff0000, v53
    v_fma_f32 v98, v112, v25, v98
    v_fma_f32 v99, v113, v25, v99
    v_lshlrev_b32 v112, 16, v54
    v_and_b32 v113, 0xffff0000, v54
    v_fma_f32 v100, v112, v25, v100
    v_fma_f32 v101, v113, v25, v101
    v_lshlrev_b32 v112, 16, v55
    v_and_b32 v113, 0xffff0000, v55
    v_fma_f32 v102, v112, v25, v102
    v_fma_f32 v103, v113, v25, v103
    v_lshlrev_b32 v112, 16, v56
    v_and_b32 v113, 0xffff0000, v56
    v_fma_f32 v88, v112, v26, v88
    v_fma_f32 v89, v113, v26, v89
    v_lshlrev_b32 v112, 16, v57
    v_and_b32 v113, 0xffff0000, v57
    v_fma_f32 v90, v112, v26, v90
    v_fma_f32 v91, v113, v26, v91
    v_lshlrev_b32 v112, 16, v58
    v_and_b32 v113, 0xffff0000, v58
    v_fma_f32 v92, v112, v26, v92
    v_fma_f32 v93, v113, v26, v93
    v_lshlrev_b32 v112, 16, v59
    v_and_b32 v113, 0xffff0000, v59
    v_fma_f32 v94, v112, v26, v94
    v_fma_f32 v95, v113, v26, v95
    v_lshlrev_b32 v112, 16, v60
    v_and_b32 v113, 0xffff0000, v60
    v_fma_f32 v96, v112, v26, v96
    v_fma_f32 v97, v113, v26, v97
    v_lshlrev_b32 v112, 16, v61
    v_and_b32 v113, 0xffff0000, v61
    v_fma_f32 v98, v112, v26, v98
    v_fma_f32 v99, v113, v26, v99
    v_lshlrev_b32 v112, 16, v62
    v_and_b32 v113, 0xffff0000, v62
    v_fma_f32 v100, v112, v26, v100
    v_fma_f32 v101, v113, v26, v101
    v_lshlrev_b32 v112, 16, v63
    v_and_b32 v113, 0xffff0000, v63
    v_fma_f32 v102, v112, v26, v102
    v_fma_f32 v103, v113, v26, v103
    v_lshlrev_b32 v112, 16, v64
    v_and_b32 v113, 0xffff0000, v64
    v_fma_f32 v88, v112, v27, v88
    v_fma_f32 v89, v113, v27, v89
    v_lshlrev_b32 v112, 16, v65
    v_and_b32 v113, 0xffff0000, v65
    v_fma_f32 v90, v112, v27, v90
    v_fma_f32 v91, v113, v27, v91
    v_lshlrev_b32 v112, 16, v66
    v_and_b32 v113, 0xffff0000, v66
    v_fma_f32 v92, v112, v27, v92
    v_fma_f32 v93, v113, v27, v93
    v_lshlrev_b32 v112, 16, v67
    v_and_b32 v113, 0xffff0000, v67
    v_fma_f32 v94, v112, v27, v94
    v_fma_f32 v95, v113, v27, v95
    v_lshlrev_b32 v112, 16, v68
    v_and_b32 v113, 0xffff0000, v68
    v_fma_f32 v96, v112, v27, v96
    v_fma_f32 v97, v113, v27, v97
    v_lshlrev_b32 v112, 16, v69
    v_and_b32 v113, 0xffff0000, v69
    v_fma_f32 v98, v112, v27, v98
    v_fma_f32 v99, v113, v27, v99
    v_lshlrev_b32 v112, 16, v70
    v_and_b32 v113, 0xffff0000, v70
    v_fma_f32 v100, v112, v27, v100
    v_fma_f32 v101, v113, v27, v101
    v_lshlrev_b32 v112, 16, v71
    v_and_b32 v113, 0xffff0000, v71
    v_fma_f32 v102, v112, v27, v102
    v_fma_f32 v103, v113, v27, v103
    v_lshlrev_b32 v24, 6, v21
    v_lshlrev_b32 v25, 5, v20
    v_add_u32 v24, v24, v25
    ds_write_b128 v24, v[88:91] offset:2048
    ds_write_b128 v24, v[92:95] offset:2064
    ds_write_b128 v24, v[96:99] offset:10240
    ds_write_b128 v24, v[100:103] offset:10256
    s_waitcnt lgkmcnt(0)
    s_barrier
    v_and_b32 v24, 15, v0
    v_lshrrev_b32 v25, 4, v0
    v_lshlrev_b32 v26, 9, v25
    v_lshlrev_b32 v27, 2, v24
    v_add_u32 v26, v26, v27
    ds_read_b32 v28, v26 offset:2048
    ds_read_b32 v4, v26 offset:10240
    ds_read_b32 v29, v26 offset:2112
    ds_read_b32 v5, v26 offset:10304
    ds_read_b32 v30, v26 offset:2176
    ds_read_b32 v6, v26 offset:10368
    ds_read_b32 v31, v26 offset:2240
    ds_read_b32 v7, v26 offset:10432
    ds_read_b32 v32, v26 offset:2304
    ds_read_b32 v8, v26 offset:10496
    ds_read_b32 v33, v26 offset:2368
    ds_read_b32 v9, v26 offset:10560
    ds_read_b32 v34, v26 offset:2432
    ds_read_b32 v10, v26 offset:10624
    ds_read_b32 v35, v26 offset:2496
    ds_read_b32 v11, v26 offset:10688
    s_waitcnt lgkmcnt(0)
    v_add_f32 v28, v28, v29
    v_add_f32 v4, v4, v5
    v_add_f32 v28, v28, v30
    v_add_f32 v4, v4, v6
    v_add_f32 v28, v28, v31
    v_add_f32 v4, v4, v7
    v_add_f32 v28, v28, v32
    v_add_f32 v4, v4, v8
    v_add_f32 v28, v28, v33
    v_add_f32 v4, v4, v9
    v_add_f32 v28, v28, v34
    v_add_f32 v4, v4, v10
    v_add_f32 v28, v28, v35
    v_add_f32 v4, v4, v11
    v_lshlrev_b32 v26, 2, v0
    ds_write_b32 v26, v28 offset:18752
    ds_write_b32 v26, v4 offset:19776
    s_waitcnt lgkmcnt(0)
    s_barrier
    v_cmp_gt_u32 vcc, 16, v0
    s_nop 3
    s_and_saveexec_b64 s[6:7], vcc
    v_lshlrev_b32 v24, 2, v0
    v_mov_b32 v26, 0
    v_mov_b32 v27, 0
    ds_read_b32 v28, v24 offset:18752
    ds_read_b32 v4, v24 offset:19776
    ds_read_b32 v29, v24 offset:18816
    ds_read_b32 v5, v24 offset:19840
    ds_read_b32 v30, v24 offset:18880
    ds_read_b32 v6, v24 offset:19904
    ds_read_b32 v31, v24 offset:18944
    ds_read_b32 v7, v24 offset:19968
    ds_read_b32 v32, v24 offset:19008
    ds_read_b32 v8, v24 offset:20032
    ds_read_b32 v33, v24 offset:19072
    ds_read_b32 v9, v24 offset:20096
    ds_read_b32 v34, v24 offset:19136
    ds_read_b32 v10, v24 offset:20160
    ds_read_b32 v35, v24 offset:19200
    ds_read_b32 v11, v24 offset:20224
    s_waitcnt lgkmcnt(0)
    v_add_f32 v26, v26, v28
    v_add_f32 v27, v27, v4
    v_add_f32 v26, v26, v29
    v_add_f32 v27, v27, v5
    v_add_f32 v26, v26, v30
    v_add_f32 v27, v27, v6
    v_add_f32 v26, v26, v31
    v_add_f32 v27, v27, v7
    v_add_f32 v26, v26, v32
    v_add_f32 v27, v27, v8
    v_add_f32 v26, v26, v33
    v_add_f32 v27, v27, v9
    v_add_f32 v26, v26, v34
    v_add_f32 v27, v27, v10
    v_add_f32 v26, v26, v35
    v_add_f32 v27, v27, v11
    ds_read_b32 v28, v24 offset:19264
    ds_read_b32 v4, v24 offset:20288
    ds_read_b32 v29, v24 offset:19328
    ds_read_b32 v5, v24 offset:20352
    ds_read_b32 v30, v24 offset:19392
    ds_read_b32 v6, v24 offset:20416
    ds_read_b32 v31, v24 offset:19456
    ds_read_b32 v7, v24 offset:20480
    ds_read_b32 v32, v24 offset:19520
    ds_read_b32 v8, v24 offset:20544
    ds_read_b32 v33, v24 offset:19584
    ds_read_b32 v9, v24 offset:20608
    ds_read_b32 v34, v24 offset:19648
    ds_read_b32 v10, v24 offset:20672
    ds_read_b32 v35, v24 offset:19712
    ds_read_b32 v11, v24 offset:20736
    s_waitcnt lgkmcnt(0)
    v_add_f32 v26, v26, v28
    v_add_f32 v27, v27, v4
    v_add_f32 v26, v26, v29
    v_add_f32 v27, v27, v5
    v_add_f32 v26, v26, v30
    v_add_f32 v27, v27, v6
    v_add_f32 v26, v26, v31
    v_add_f32 v27, v27, v7
    v_add_f32 v26, v26, v32
    v_add_f32 v27, v27, v8
    v_add_f32 v26, v26, v33
    v_add_f32 v27, v27, v9
    v_add_f32 v26, v26, v34
    v_add_f32 v27, v27, v10
    v_add_f32 v26, v26, v35
    v_add_f32 v27, v27, v11
    v_cvt_pk_bf16_f32 v28, v26, v26
    v_lshlrev_b32 v26, 16, v28
    v_cvt_pk_bf16_f32 v28, v27, v27
    v_lshlrev_b32 v27, 16, v28
    v_mul_f32 v30, 0x3fb8aa3b, v26
    v_exp_f32 v30, -v30
    s_nop 0
    v_add_f32 v30, 1.0, v30
    v_rcp_f32 v30, v30
    s_nop 0
    v_mul_f32 v29, v26, v30
    v_cvt_pk_bf16_f32 v28, v29, v29
    v_lshlrev_b32 v29, 16, v28
    v_mul_f32 v29, v29, v27
    v_cvt_pk_bf16_f32 v28, v29, v29
    v_lshlrev_b32 v29, 16, v28
    ds_write_b32 v24, v29 offset:18432
    s_mov_b64 exec, s[6:7]
    s_waitcnt lgkmcnt(0)
    s_barrier
    v_cmp_gt_u32 vcc, 224, v0
    s_nop 3
    s_and_saveexec_b64 s[6:7], vcc
    v_lshlrev_b32 v23, 4, v36
    v_mov_b32 v104, 0
    v_mov_b32 v105, 0
    v_mov_b32 v106, 0
    v_mov_b32 v107, 0
    v_mov_b32 v108, 0
    v_mov_b32 v109, 0
    v_mov_b32 v110, 0
    v_mov_b32 v111, 0
    ds_read_b128 v[4:7], v23 offset:18432
    s_waitcnt lgkmcnt(0)
    v_lshlrev_b32 v112, 16, v72
    v_and_b32 v113, 0xffff0000, v72
    v_fma_f32 v104, v112, v4, v104
    v_fma_f32 v105, v113, v4, v105
    v_lshlrev_b32 v112, 16, v73
    v_and_b32 v113, 0xffff0000, v73
    v_fma_f32 v106, v112, v4, v106
    v_fma_f32 v107, v113, v4, v107
    v_lshlrev_b32 v112, 16, v74
    v_and_b32 v113, 0xffff0000, v74
    v_fma_f32 v108, v112, v4, v108
    v_fma_f32 v109, v113, v4, v109
    v_lshlrev_b32 v112, 16, v75
    v_and_b32 v113, 0xffff0000, v75
    v_fma_f32 v110, v112, v4, v110
    v_fma_f32 v111, v113, v4, v111
    v_lshlrev_b32 v112, 16, v76
    v_and_b32 v113, 0xffff0000, v76
    v_fma_f32 v104, v112, v5, v104
    v_fma_f32 v105, v113, v5, v105
    v_lshlrev_b32 v112, 16, v77
    v_and_b32 v113, 0xffff0000, v77
    v_fma_f32 v106, v112, v5, v106
    v_fma_f32 v107, v113, v5, v107
    v_lshlrev_b32 v112, 16, v78
    v_and_b32 v113, 0xffff0000, v78
    v_fma_f32 v108, v112, v5, v108
    v_fma_f32 v109, v113, v5, v109
    v_lshlrev_b32 v112, 16, v79
    v_and_b32 v113, 0xffff0000, v79
    v_fma_f32 v110, v112, v5, v110
    v_fma_f32 v111, v113, v5, v111
    v_lshlrev_b32 v112, 16, v80
    v_and_b32 v113, 0xffff0000, v80
    v_fma_f32 v104, v112, v6, v104
    v_fma_f32 v105, v113, v6, v105
    v_lshlrev_b32 v112, 16, v81
    v_and_b32 v113, 0xffff0000, v81
    v_fma_f32 v106, v112, v6, v106
    v_fma_f32 v107, v113, v6, v107
    v_lshlrev_b32 v112, 16, v82
    v_and_b32 v113, 0xffff0000, v82
    v_fma_f32 v108, v112, v6, v108
    v_fma_f32 v109, v113, v6, v109
    v_lshlrev_b32 v112, 16, v83
    v_and_b32 v113, 0xffff0000, v83
    v_fma_f32 v110, v112, v6, v110
    v_fma_f32 v111, v113, v6, v111
    v_lshlrev_b32 v112, 16, v84
    v_and_b32 v113, 0xffff0000, v84
    v_fma_f32 v104, v112, v7, v104
    v_fma_f32 v105, v113, v7, v105
    v_lshlrev_b32 v112, 16, v85
    v_and_b32 v113, 0xffff0000, v85
    v_fma_f32 v106, v112, v7, v106
    v_fma_f32 v107, v113, v7, v107
    v_lshlrev_b32 v112, 16, v86
    v_and_b32 v113, 0xffff0000, v86
    v_fma_f32 v108, v112, v7, v108
    v_fma_f32 v109, v113, v7, v109
    v_lshlrev_b32 v112, 16, v87
    v_and_b32 v113, 0xffff0000, v87
    v_fma_f32 v110, v112, v7, v110
    v_fma_f32 v111, v113, v7, v111
    v_mul_u32_u24 v24, 1792, v36
    v_lshlrev_b32 v25, 5, v37
    v_add_u32 v24, v24, v25
    ds_write_b128 v24, v[104:107] offset:2048
    ds_write_b128 v24, v[108:111] offset:2064
    s_mov_b64 exec, s[6:7]
    s_waitcnt lgkmcnt(0)
    s_barrier
    v_cmp_gt_u32 vcc, 224, v0
    s_nop 3
    s_and_saveexec_b64 s[6:7], vcc
    v_lshlrev_b32 v24, 3, v0
    ds_read_b64 v[28:29], v24 offset:2048
    ds_read_b64 v[30:31], v24 offset:3840
    ds_read_b64 v[32:33], v24 offset:5632
    ds_read_b64 v[34:35], v24 offset:7424
    s_waitcnt lgkmcnt(0)
    v_add_f32 v28, v28, v30
    v_add_f32 v29, v29, v31
    v_add_f32 v32, v32, v34
    v_add_f32 v33, v33, v35
    v_add_f32 v28, v28, v32
    v_add_f32 v29, v29, v33
    s_mul_i32 s5, s4, 1792
    s_add_u32 s5, s5, 4243456
    buffer_store_dwordx2 v[28:29], v24, s[56:59], s5 offen
    s_mov_b64 exec, s[6:7]
    s_cmp_lg_u32 s4, 0
    s_cbranch_scc1 L_mod_end
    v_cvt_pk_bf16_f32 v21, v16, v16
    v_lshlrev_b32 v20, 16, v21
    v_mul_f32 v21, 0x3fb8aa3b, v20
    v_exp_f32 v21, -v21
    s_nop 0
    v_add_f32 v21, 1.0, v21
    v_rcp_f32 v21, v21
    s_nop 0
    v_cvt_pk_bf16_f32 v22, v21, v21
    v_lshlrev_b32 v21, 16, v22
    v_mov_b32 v22, v17
    v_mov_b32 v23, v21
    v_cmp_eq_u32 vcc, 0, v0
    s_nop 3
    s_and_saveexec_b64 s[6:7], vcc
    v_mov_b32 v24, 0
    s_mov_b32 s5, 4235264
    buffer_store_dwordx2 v[22:23], v24, s[56:59], s5 offen
    s_mov_b64 exec, s[6:7]
L_mod_end:
    s_endpgm
L_attn_modx:
    s_endpgm
.section .rodata,"a"
.p2align 6
.amdhsa_kernel attn_kernel
  .amdhsa_next_free_vgpr 128
  .amdhsa_next_free_sgpr 102
  .amdhsa_accum_offset 128
  .amdhsa_group_segment_fixed_size 0
  .amdhsa_kernarg_size 88
  .amdhsa_user_sgpr_count 2
  .amdhsa_user_sgpr_kernarg_segment_ptr 1
  .amdhsa_system_sgpr_workgroup_id_x 1
.end_amdhsa_kernel
.text
.globl out_kernel
.p2align 8
.type out_kernel,@function
out_kernel:
    s_cmp_ge_u32 s2, 256
    s_cbranch_scc1 L_out_end
    s_load_dwordx16 s[16:31], s[0:1], 0
    s_load_dwordx4 s[32:35], s[0:1], 64
    s_load_dwordx2 s[36:37], s[0:1], 80
    v_and_b32 v1, 63, v0
    v_lshrrev_b32 v2, 6, v0
    v_lshlrev_b32 v3, 4, v1
    v_readfirstlane_b32 s6, v2
    s_lshr_b32 s4, s2, 2
    s_and_b32 s5, s2, 3
    s_waitcnt lgkmcnt(0)
    s_add_u32 s78, s36, 4235264
    s_addc_u32 s79, s37, 0
    s_load_dwordx2 s[80:81], s[78:79], 0
    s_lshl_b32 s7, s5, 2
    s_add_u32 s7, s7, s6
    s_cmp_ge_u32 s7, 14
    s_cbranch_scc1 L_out_end
    s_mov_b32 s56, s36
    s_and_b32 s57, s37, 0xffff
    s_mov_b32 s58, 16777216
    s_mov_b32 s59, 0x00020000
    s_mov_b32 s40, s16
    s_and_b32 s41, s17, 0xffff
    s_mov_b32 s42, 1835008
    s_mov_b32 s43, 0x00020000
    s_mov_b32 s44, s32
    s_and_b32 s45, s33, 0xffff
    s_mov_b32 s46, 1835008
    s_mov_b32 s47, 0x00020000
    s_lshl_b32 s8, s4, 15
    s_add_u32 s8, s8, 12582912
    s_lshl_b32 s9, s7, 15
    s_add_u32 s9, s9, 3670016
    s_add_u32 s10, s8, 0
    s_add_u32 s11, s9, 0
    buffer_load_dwordx4 v[32:35], v3, s[56:59], s10 offen
    buffer_load_dwordx4 v[36:39], v3, s[56:59], s11 offen
    s_add_u32 s10, s8, 1024
    s_add_u32 s11, s9, 1024
    buffer_load_dwordx4 v[40:43], v3, s[56:59], s10 offen
    buffer_load_dwordx4 v[44:47], v3, s[56:59], s11 offen
    s_add_u32 s10, s8, 2048
    s_add_u32 s11, s9, 2048
    buffer_load_dwordx4 v[48:51], v3, s[56:59], s10 offen
    buffer_load_dwordx4 v[52:55], v3, s[56:59], s11 offen
    s_add_u32 s10, s8, 3072
    s_add_u32 s11, s9, 3072
    buffer_load_dwordx4 v[56:59], v3, s[56:59], s10 offen
    buffer_load_dwordx4 v[60:63], v3, s[56:59], s11 offen
    s_add_u32 s10, s8, 4096
    s_add_u32 s11, s9, 4096
    buffer_load_dwordx4 v[64:67], v3, s[56:59], s10 offen
    buffer_load_dwordx4 v[68:71], v3, s[56:59], s11 offen
    s_add_u32 s10, s8, 5120
    s_add_u32 s11, s9, 5120
    buffer_load_dwordx4 v[72:75], v3, s[56:59], s10 offen
    buffer_load_dwordx4 v[76:79], v3, s[56:59], s11 offen
    s_add_u32 s10, s8, 6144
    s_add_u32 s11, s9, 6144
    buffer_load_dwordx4 v[80:83], v3, s[56:59], s10 offen
    buffer_load_dwordx4 v[84:87], v3, s[56:59], s11 offen
    s_add_u32 s10, s8, 7168
    s_add_u32 s11, s9, 7168
    buffer_load_dwordx4 v[88:91], v3, s[56:59], s10 offen
    buffer_load_dwordx4 v[92:95], v3, s[56:59], s11 offen
    s_add_u32 s10, s8, 8192
    s_add_u32 s11, s9, 8192
    buffer_load_dwordx4 v[96:99], v3, s[56:59], s10 offen
    buffer_load_dwordx4 v[100:103], v3, s[56:59], s11 offen
    s_add_u32 s10, s8, 9216
    s_add_u32 s11, s9, 9216
    buffer_load_dwordx4 v[104:107], v3, s[56:59], s10 offen
    buffer_load_dwordx4 v[108:111], v3, s[56:59], s11 offen
    s_add_u32 s10, s8, 10240
    s_add_u32 s11, s9, 10240
    buffer_load_dwordx4 v[112:115], v3, s[56:59], s10 offen
    buffer_load_dwordx4 v[116:119], v3, s[56:59], s11 offen
    s_add_u32 s10, s8, 11264
    s_add_u32 s11, s9, 11264
    buffer_load_dwordx4 v[120:123], v3, s[56:59], s10 offen
    buffer_load_dwordx4 v[124:127], v3, s[56:59], s11 offen
    s_add_u32 s10, s8, 12288
    s_add_u32 s11, s9, 12288
    buffer_load_dwordx4 v[128:131], v3, s[56:59], s10 offen
    buffer_load_dwordx4 v[132:135], v3, s[56:59], s11 offen
    s_add_u32 s10, s8, 13312
    s_add_u32 s11, s9, 13312
    buffer_load_dwordx4 v[136:139], v3, s[56:59], s10 offen
    buffer_load_dwordx4 v[140:143], v3, s[56:59], s11 offen
    s_add_u32 s10, s8, 14336
    s_add_u32 s11, s9, 14336
    buffer_load_dwordx4 v[144:147], v3, s[56:59], s10 offen
    buffer_load_dwordx4 v[148:151], v3, s[56:59], s11 offen
    s_add_u32 s10, s8, 15360
    s_add_u32 s11, s9, 15360
    buffer_load_dwordx4 v[152:155], v3, s[56:59], s10 offen
    buffer_load_dwordx4 v[156:159], v3, s[56:59], s11 offen
    v_mov_b32 v16, 0
    v_mov_b32 v17, 0
    v_mov_b32 v18, 0
    v_mov_b32 v19, 0
    v_mov_b32 v20, 0
    v_mov_b32 v21, 0
    v_mov_b32 v22, 0
    v_mov_b32 v23, 0
    v_mov_b32 v24, 0
    v_mov_b32 v25, 0
    v_mov_b32 v26, 0
    v_mov_b32 v27, 0
    v_mov_b32 v28, 0
    v_mov_b32 v29, 0
    v_mov_b32 v30, 0
    v_mov_b32 v31, 0
    s_waitcnt vmcnt(30)
    s_nop 0
    v_mfma_f32_32x32x16_bf16 v[16:31], v[36:39], v[32:35], v[16:31]
    s_waitcnt vmcnt(28)
    v_mfma_f32_32x32x16_bf16 v[16:31], v[44:47], v[40:43], v[16:31]
    s_waitcnt vmcnt(26)
    v_mfma_f32_32x32x16_bf16 v[16:31], v[52:55], v[48:51], v[16:31]
    s_waitcnt vmcnt(24)
    v_mfma_f32_32x32x16_bf16 v[16:31], v[60:63], v[56:59], v[16:31]
    s_waitcnt vmcnt(22)
    v_mfma_f32_32x32x16_bf16 v[16:31], v[68:71], v[64:67], v[16:31]
    s_waitcnt vmcnt(20)
    v_mfma_f32_32x32x16_bf16 v[16:31], v[76:79], v[72:75], v[16:31]
    s_waitcnt vmcnt(18)
    v_mfma_f32_32x32x16_bf16 v[16:31], v[84:87], v[80:83], v[16:31]
    s_waitcnt vmcnt(16)
    v_mfma_f32_32x32x16_bf16 v[16:31], v[92:95], v[88:91], v[16:31]
    s_add_u32 s10, s8, 16384
    s_add_u32 s11, s9, 16384
    buffer_load_dwordx4 v[32:35], v3, s[56:59], s10 offen
    buffer_load_dwordx4 v[36:39], v3, s[56:59], s11 offen
    s_add_u32 s10, s8, 17408
    s_add_u32 s11, s9, 17408
    buffer_load_dwordx4 v[40:43], v3, s[56:59], s10 offen
    buffer_load_dwordx4 v[44:47], v3, s[56:59], s11 offen
    s_add_u32 s10, s8, 18432
    s_add_u32 s11, s9, 18432
    buffer_load_dwordx4 v[48:51], v3, s[56:59], s10 offen
    buffer_load_dwordx4 v[52:55], v3, s[56:59], s11 offen
    s_add_u32 s10, s8, 19456
    s_add_u32 s11, s9, 19456
    buffer_load_dwordx4 v[56:59], v3, s[56:59], s10 offen
    buffer_load_dwordx4 v[60:63], v3, s[56:59], s11 offen
    s_add_u32 s10, s8, 20480
    s_add_u32 s11, s9, 20480
    buffer_load_dwordx4 v[64:67], v3, s[56:59], s10 offen
    buffer_load_dwordx4 v[68:71], v3, s[56:59], s11 offen
    s_add_u32 s10, s8, 21504
    s_add_u32 s11, s9, 21504
    buffer_load_dwordx4 v[72:75], v3, s[56:59], s10 offen
    buffer_load_dwordx4 v[76:79], v3, s[56:59], s11 offen
    s_add_u32 s10, s8, 22528
    s_add_u32 s11, s9, 22528
    buffer_load_dwordx4 v[80:83], v3, s[56:59], s10 offen
    buffer_load_dwordx4 v[84:87], v3, s[56:59], s11 offen
    s_add_u32 s10, s8, 23552
    s_add_u32 s11, s9, 23552
    buffer_load_dwordx4 v[88:91], v3, s[56:59], s10 offen
    buffer_load_dwordx4 v[92:95], v3, s[56:59], s11 offen
    s_waitcnt vmcnt(30)
    v_mfma_f32_32x32x16_bf16 v[16:31], v[100:103], v[96:99], v[16:31]
    s_waitcnt vmcnt(28)
    v_mfma_f32_32x32x16_bf16 v[16:31], v[108:111], v[104:107], v[16:31]
    s_waitcnt vmcnt(26)
    v_mfma_f32_32x32x16_bf16 v[16:31], v[116:119], v[112:115], v[16:31]
    s_waitcnt vmcnt(24)
    v_mfma_f32_32x32x16_bf16 v[16:31], v[124:127], v[120:123], v[16:31]
    s_waitcnt vmcnt(22)
    v_mfma_f32_32x32x16_bf16 v[16:31], v[132:135], v[128:131], v[16:31]
    s_waitcnt vmcnt(20)
    v_mfma_f32_32x32x16_bf16 v[16:31], v[140:143], v[136:139], v[16:31]
    s_waitcnt vmcnt(18)
    v_mfma_f32_32x32x16_bf16 v[16:31], v[148:151], v[144:147], v[16:31]
    s_waitcnt vmcnt(16)
    v_mfma_f32_32x32x16_bf16 v[16:31], v[156:159], v[152:155], v[16:31]
    s_add_u32 s10, s8, 24576
    s_add_u32 s11, s9, 24576
    buffer_load_dwordx4 v[96:99], v3, s[56:59], s10 offen
    buffer_load_dwordx4 v[100:103], v3, s[56:59], s11 offen
    s_add_u32 s10, s8, 25600
    s_add_u32 s11, s9, 25600
    buffer_load_dwordx4 v[104:107], v3, s[56:59], s10 offen
    buffer_load_dwordx4 v[108:111], v3, s[56:59], s11 offen
    s_add_u32 s10, s8, 26624
    s_add_u32 s11, s9, 26624
    buffer_load_dwordx4 v[112:115], v3, s[56:59], s10 offen
    buffer_load_dwordx4 v[116:119], v3, s[56:59], s11 offen
    s_add_u32 s10, s8, 27648
    s_add_u32 s11, s9, 27648
    buffer_load_dwordx4 v[120:123], v3, s[56:59], s10 offen
    buffer_load_dwordx4 v[124:127], v3, s[56:59], s11 offen
    s_add_u32 s10, s8, 28672
    s_add_u32 s11, s9, 28672
    buffer_load_dwordx4 v[128:131], v3, s[56:59], s10 offen
    buffer_load_dwordx4 v[132:135], v3, s[56:59], s11 offen
    s_add_u32 s10, s8, 29696
    s_add_u32 s11, s9, 29696
    buffer_load_dwordx4 v[136:139], v3, s[56:59], s10 offen
    buffer_load_dwordx4 v[140:143], v3, s[56:59], s11 offen
    s_add_u32 s10, s8, 30720
    s_add_u32 s11, s9, 30720
    buffer_load_dwordx4 v[144:147], v3, s[56:59], s10 offen
    buffer_load_dwordx4 v[148:151], v3, s[56:59], s11 offen
    s_add_u32 s10, s8, 31744
    s_add_u32 s11, s9, 31744
    buffer_load_dwordx4 v[152:155], v3, s[56:59], s10 offen
    buffer_load_dwordx4 v[156:159], v3, s[56:59], s11 offen
    s_waitcnt vmcnt(30)
    v_mfma_f32_32x32x16_bf16 v[16:31], v[36:39], v[32:35], v[16:31]
    s_waitcnt vmcnt(28)
    v_mfma_f32_32x32x16_bf16 v[16:31], v[44:47], v[40:43], v[16:31]
    s_waitcnt vmcnt(26)
    v_mfma_f32_32x32x16_bf16 v[16:31], v[52:55], v[48:51], v[16:31]
    s_waitcnt vmcnt(24)
    v_mfma_f32_32x32x16_bf16 v[16:31], v[60:63], v[56:59], v[16:31]
    s_waitcnt vmcnt(22)
    v_mfma_f32_32x32x16_bf16 v[16:31], v[68:71], v[64:67], v[16:31]
    s_waitcnt vmcnt(20)
    v_mfma_f32_32x32x16_bf16 v[16:31], v[76:79], v[72:75], v[16:31]
    s_waitcnt vmcnt(18)
    v_mfma_f32_32x32x16_bf16 v[16:31], v[84:87], v[80:83], v[16:31]
    s_waitcnt vmcnt(16)
    v_mfma_f32_32x32x16_bf16 v[16:31], v[92:95], v[88:91], v[16:31]
    s_waitcnt vmcnt(14)
    v_mfma_f32_32x32x16_bf16 v[16:31], v[100:103], v[96:99], v[16:31]
    s_waitcnt vmcnt(12)
    v_mfma_f32_32x32x16_bf16 v[16:31], v[108:111], v[104:107], v[16:31]
    s_waitcnt vmcnt(10)
    v_mfma_f32_32x32x16_bf16 v[16:31], v[116:119], v[112:115], v[16:31]
    s_waitcnt vmcnt(8)
    v_mfma_f32_32x32x16_bf16 v[16:31], v[124:127], v[120:123], v[16:31]
    s_waitcnt vmcnt(6)
    v_mfma_f32_32x32x16_bf16 v[16:31], v[132:135], v[128:131], v[16:31]
    s_waitcnt vmcnt(4)
    v_mfma_f32_32x32x16_bf16 v[16:31], v[140:143], v[136:139], v[16:31]
    s_waitcnt vmcnt(2)
    v_mfma_f32_32x32x16_bf16 v[16:31], v[148:151], v[144:147], v[16:31]
    s_waitcnt vmcnt(0)
    v_mfma_f32_32x32x16_bf16 v[16:31], v[156:159], v[152:155], v[16:31]
    v_and_b32 v4, 31, v1
    v_lshrrev_b32 v5, 5, v1
    v_mul_u32_u24 v6, 896, v4
    v_lshlrev_b32 v7, 3, v5
    v_add_u32 v6, v6, v7
    s_mul_i32 s10, s4, 28672
    s_lshl_b32 s11, s7, 6
    s_add_u32 s10, s10, s11
    v_lshlrev_b32 v8, 3, v4
    s_lshl_b32 s11, s4, 8
    s_add_u32 s11, s11, 4194304
    buffer_load_dwordx2 v[160:161], v8, s[56:59], s11 offen
    buffer_load_dwordx2 v[162:163], v6, s[40:43], s10 offen offset:0
    buffer_load_dwordx2 v[164:165], v6, s[40:43], s10 offen offset:16
    buffer_load_dwordx2 v[166:167], v6, s[40:43], s10 offen offset:32
    buffer_load_dwordx2 v[168:169], v6, s[40:43], s10 offen offset:48
    s_waitcnt lgkmcnt(0)
    s_lshr_b32 s82, s80, 5
    v_mov_b32 v172, 0
    v_mov_b32 v173, 0
    v_mov_b32 v174, 0
    v_mov_b32 v175, 0
    v_mov_b32 v176, 0
    v_mov_b32 v177, 0
    v_mov_b32 v178, 0
    v_mov_b32 v179, 0
    v_mov_b32 v180, 0
    v_mov_b32 v181, 0
    v_mov_b32 v182, 0
    v_mov_b32 v183, 0
    v_mov_b32 v184, 0
    v_mov_b32 v185, 0
    v_mov_b32 v186, 0
    v_mov_b32 v187, 0
    s_cmp_lg_u32 s82, s4
    s_cbranch_scc1 L_out_noupd
    v_and_b32 v9, 31, v1
    v_lshlrev_b32 v9, 2, v9
    s_lshl_b32 s12, s7, 7
    s_add_u32 s12, s12, 4243456
    v_lshrrev_b32 v10, 5, v1
    v_mul_u32_u24 v10, 100352, v10
    v_add_u32 v10, v10, v9
    s_add_u32 s13, s12, 0
    buffer_load_dword v216, v10, s[56:59], s13 offen
    s_add_u32 s13, s12, 1792
    buffer_load_dword v217, v10, s[56:59], s13 offen
    s_add_u32 s13, s12, 3584
    buffer_load_dword v218, v10, s[56:59], s13 offen
    s_add_u32 s13, s12, 5376
    buffer_load_dword v219, v10, s[56:59], s13 offen
    s_add_u32 s13, s12, 7168
    buffer_load_dword v220, v10, s[56:59], s13 offen
    s_add_u32 s13, s12, 8960
    buffer_load_dword v221, v10, s[56:59], s13 offen
    s_add_u32 s13, s12, 10752
    buffer_load_dword v222, v10, s[56:59], s13 offen
    s_add_u32 s13, s12, 12544
    buffer_load_dword v223, v10, s[56:59], s13 offen
    s_add_u32 s13, s12, 14336
    buffer_load_dword v224, v10, s[56:59], s13 offen
    s_add_u32 s13, s12, 16128
    buffer_load_dword v225, v10, s[56:59], s13 offen
    s_add_u32 s13, s12, 17920
    buffer_load_dword v226, v10, s[56:59], s13 offen
    s_add_u32 s13, s12, 19712
    buffer_load_dword v227, v10, s[56:59], s13 offen
    s_add_u32 s13, s12, 21504
    buffer_load_dword v228, v10, s[56:59], s13 offen
    s_add_u32 s13, s12, 23296
    buffer_load_dword v229, v10, s[56:59], s13 offen
    s_add_u32 s13, s12, 25088
    buffer_load_dword v230, v10, s[56:59], s13 offen
    s_add_u32 s13, s12, 26880
    buffer_load_dword v231, v10, s[56:59], s13 offen
    s_add_u32 s13, s12, 28672
    buffer_load_dword v232, v10, s[56:59], s13 offen
    s_add_u32 s13, s12, 30464
    buffer_load_dword v233, v10, s[56:59], s13 offen
    s_add_u32 s13, s12, 32256
    buffer_load_dword v234, v10, s[56:59], s13 offen
    s_add_u32 s13, s12, 34048
    buffer_load_dword v235, v10, s[56:59], s13 offen
    s_add_u32 s13, s12, 35840
    buffer_load_dword v236, v10, s[56:59], s13 offen
    s_add_u32 s13, s12, 37632
    buffer_load_dword v237, v10, s[56:59], s13 offen
    s_add_u32 s13, s12, 39424
    buffer_load_dword v238, v10, s[56:59], s13 offen
    s_add_u32 s13, s12, 41216
    buffer_load_dword v239, v10, s[56:59], s13 offen
    s_add_u32 s13, s12, 43008
    buffer_load_dword v240, v10, s[56:59], s13 offen
    s_add_u32 s13, s12, 44800
    buffer_load_dword v241, v10, s[56:59], s13 offen
    s_add_u32 s13, s12, 46592
    buffer_load_dword v242, v10, s[56:59], s13 offen
    s_add_u32 s13, s12, 48384
    buffer_load_dword v243, v10, s[56:59], s13 offen
    s_add_u32 s13, s12, 50176
    buffer_load_dword v244, v10, s[56:59], s13 offen
    s_add_u32 s13, s12, 51968
    buffer_load_dword v245, v10, s[56:59], s13 offen
    s_add_u32 s13, s12, 53760
    buffer_load_dword v246, v10, s[56:59], s13 offen
    s_add_u32 s13, s12, 55552
    buffer_load_dword v247, v10, s[56:59], s13 offen
    s_add_u32 s13, s12, 57344
    buffer_load_dword v248, v10, s[56:59], s13 offen
    s_add_u32 s13, s12, 59136
    buffer_load_dword v249, v10, s[56:59], s13 offen
    s_add_u32 s13, s12, 60928
    buffer_load_dword v250, v10, s[56:59], s13 offen
    s_add_u32 s13, s12, 62720
    buffer_load_dword v251, v10, s[56:59], s13 offen
    s_add_u32 s13, s12, 64512
    buffer_load_dword v252, v10, s[56:59], s13 offen
    s_add_u32 s13, s12, 66304
    buffer_load_dword v253, v10, s[56:59], s13 offen
    s_add_u32 s13, s12, 68096
    buffer_load_dword v254, v10, s[56:59], s13 offen
    s_add_u32 s13, s12, 69888
    buffer_load_dword v255, v10, s[56:59], s13 offen
    s_add_u32 s13, s12, 71680
    buffer_load_dword v104, v10, s[56:59], s13 offen
    s_add_u32 s13, s12, 73472
    buffer_load_dword v105, v10, s[56:59], s13 offen
    s_add_u32 s13, s12, 75264
    buffer_load_dword v106, v10, s[56:59], s13 offen
    s_add_u32 s13, s12, 77056
    buffer_load_dword v107, v10, s[56:59], s13 offen
    s_add_u32 s13, s12, 78848
    buffer_load_dword v108, v10, s[56:59], s13 offen
    s_add_u32 s13, s12, 80640
    buffer_load_dword v109, v10, s[56:59], s13 offen
    s_add_u32 s13, s12, 82432
    buffer_load_dword v110, v10, s[56:59], s13 offen
    s_add_u32 s13, s12, 84224
    buffer_load_dword v111, v10, s[56:59], s13 offen
    s_add_u32 s13, s12, 86016
    buffer_load_dword v112, v10, s[56:59], s13 offen
    s_add_u32 s13, s12, 87808
    buffer_load_dword v113, v10, s[56:59], s13 offen
    s_add_u32 s13, s12, 89600
    buffer_load_dword v114, v10, s[56:59], s13 offen
    s_add_u32 s13, s12, 91392
    buffer_load_dword v115, v10, s[56:59], s13 offen
    s_add_u32 s13, s12, 93184
    buffer_load_dword v116, v10, s[56:59], s13 offen
    s_add_u32 s13, s12, 94976
    buffer_load_dword v117, v10, s[56:59], s13 offen
    s_add_u32 s13, s12, 96768
    buffer_load_dword v118, v10, s[56:59], s13 offen
    s_add_u32 s13, s12, 98560
    buffer_load_dword v119, v10, s[56:59], s13 offen
    s_waitcnt vmcnt(0)
    v_mov_b32 v171, v216
    v_add_f32 v171, v171, v217
    v_add_f32 v171, v171, v218
    v_add_f32 v171, v171, v219
    v_add_f32 v171, v171, v220
    v_add_f32 v171, v171, v221
    v_add_f32 v171, v171, v222
    v_add_f32 v171, v171, v223
    v_add_f32 v171, v171, v224
    v_add_f32 v171, v171, v225
    v_add_f32 v171, v171, v226
    v_add_f32 v171, v171, v227
    v_add_f32 v171, v171, v228
    v_add_f32 v171, v171, v229
    v_add_f32 v171, v171, v230
    v_add_f32 v171, v171, v231
    v_add_f32 v171, v171, v232
    v_add_f32 v171, v171, v233
    v_add_f32 v171, v171, v234
    v_add_f32 v171, v171, v235
    v_add_f32 v171, v171, v236
    v_add_f32 v171, v171, v237
    v_add_f32 v171, v171, v238
    v_add_f32 v171, v171, v239
    v_add_f32 v171, v171, v240
    v_add_f32 v171, v171, v241
    v_add_f32 v171, v171, v242
    v_add_f32 v171, v171, v243
    v_add_f32 v171, v171, v244
    v_add_f32 v171, v171, v245
    v_add_f32 v171, v171, v246
    v_add_f32 v171, v171, v247
    v_add_f32 v171, v171, v248
    v_add_f32 v171, v171, v249
    v_add_f32 v171, v171, v250
    v_add_f32 v171, v171, v251
    v_add_f32 v171, v171, v252
    v_add_f32 v171, v171, v253
    v_add_f32 v171, v171, v254
    v_add_f32 v171, v171, v255
    v_add_f32 v171, v171, v104
    v_add_f32 v171, v171, v105
    v_add_f32 v171, v171, v106
    v_add_f32 v171, v171, v107
    v_add_f32 v171, v171, v108
    v_add_f32 v171, v171, v109
    v_add_f32 v171, v171, v110
    v_add_f32 v171, v171, v111
    v_add_f32 v171, v171, v112
    v_add_f32 v171, v171, v113
    v_add_f32 v171, v171, v114
    v_add_f32 v171, v171, v115
    v_add_f32 v171, v171, v116
    v_add_f32 v171, v171, v117
    v_add_f32 v171, v171, v118
    v_add_f32 v171, v171, v119
    v_mov_b32 v188, v171
    v_mov_b32 v189, v171
    s_nop 1
    v_permlane32_swap_b32 v188, v189
    v_add_f32 v188, v188, v189
    v_cvt_pk_bf16_f32 v189, v188, v188
    v_lshlrev_b32 v188, 16, v189
    v_mul_f32 v188, s81, v188
    v_cvt_pk_bf16_f32 v189, v188, v188
    v_lshlrev_b32 v188, 16, v189
    s_lshl_b32 s13, s6, 7
    v_add_u32 v10, s13, v9
    ds_write_b32 v10, v188
    s_waitcnt lgkmcnt(0)
    v_lshlrev_b32 v10, 4, v5
    v_add_u32 v10, s13, v10
    ds_read_b128 v[172:175], v10 offset:0
    ds_read_b128 v[176:179], v10 offset:32
    ds_read_b128 v[180:183], v10 offset:64
    ds_read_b128 v[184:187], v10 offset:96
    s_and_b32 s83, s80, 31
    v_cmp_eq_u32 vcc, s83, v4
    s_waitcnt lgkmcnt(0)
    s_nop 0
    v_cndmask_b32 v172, 0, v172, vcc
    v_cndmask_b32 v173, 0, v173, vcc
    v_cndmask_b32 v174, 0, v174, vcc
    v_cndmask_b32 v175, 0, v175, vcc
    v_cndmask_b32 v176, 0, v176, vcc
    v_cndmask_b32 v177, 0, v177, vcc
    v_cndmask_b32 v178, 0, v178, vcc
    v_cndmask_b32 v179, 0, v179, vcc
    v_cndmask_b32 v180, 0, v180, vcc
    v_cndmask_b32 v181, 0, v181, vcc
    v_cndmask_b32 v182, 0, v182, vcc
    v_cndmask_b32 v183, 0, v183, vcc
    v_cndmask_b32 v184, 0, v184, vcc
    v_cndmask_b32 v185, 0, v185, vcc
    v_cndmask_b32 v186, 0, v186, vcc
    v_cndmask_b32 v187, 0, v187, vcc
L_out_noupd:
    s_waitcnt vmcnt(0)
    v_rcp_f32 v170, v161
    v_lshlrev_b32 v200, 16, v162
    v_sub_f32 v201, v200, v160
    v_cvt_pk_bf16_f32 v202, v201, v201
    v_lshlrev_b32 v201, 16, v202
    v_mul_f32 v201, v201, v170
    v_cvt_pk_bf16_f32 v202, v201, v201
    v_lshlrev_b32 v201, 16, v202
    v_add_f32 v201, v201, v172
    v_cvt_pk_bf16_f32 v202, v201, v201
    v_lshlrev_b32 v201, 16, v202
    v_mul_f32 v204, 0x3fb8aa3b, v201
    v_exp_f32 v204, -v204
    s_nop 0
    v_add_f32 v204, 1.0, v204
    v_rcp_f32 v204, v204
    s_nop 0
    v_mul_f32 v203, v201, v204
    v_cvt_pk_bf16_f32 v202, v203, v203
    v_lshlrev_b32 v203, 16, v202
    v_cvt_pk_bf16_f32 v202, v16, v16
    v_lshlrev_b32 v16, 16, v202
    v_mul_f32 v203, v203, v16
    v_cvt_pk_bf16_f32 v202, v203, v203
    v_lshlrev_b32 v203, 16, v202
    v_add_f32 v16, v200, v203
    v_and_b32 v200, 0xffff0000, v162
    v_sub_f32 v201, v200, v160
    v_cvt_pk_bf16_f32 v202, v201, v201
    v_lshlrev_b32 v201, 16, v202
    v_mul_f32 v201, v201, v170
    v_cvt_pk_bf16_f32 v202, v201, v201
    v_lshlrev_b32 v201, 16, v202
    v_add_f32 v201, v201, v173
    v_cvt_pk_bf16_f32 v202, v201, v201
    v_lshlrev_b32 v201, 16, v202
    v_mul_f32 v204, 0x3fb8aa3b, v201
    v_exp_f32 v204, -v204
    s_nop 0
    v_add_f32 v204, 1.0, v204
    v_rcp_f32 v204, v204
    s_nop 0
    v_mul_f32 v203, v201, v204
    v_cvt_pk_bf16_f32 v202, v203, v203
    v_lshlrev_b32 v203, 16, v202
    v_cvt_pk_bf16_f32 v202, v17, v17
    v_lshlrev_b32 v17, 16, v202
    v_mul_f32 v203, v203, v17
    v_cvt_pk_bf16_f32 v202, v203, v203
    v_lshlrev_b32 v203, 16, v202
    v_add_f32 v17, v200, v203
    v_lshlrev_b32 v200, 16, v163
    v_sub_f32 v201, v200, v160
    v_cvt_pk_bf16_f32 v202, v201, v201
    v_lshlrev_b32 v201, 16, v202
    v_mul_f32 v201, v201, v170
    v_cvt_pk_bf16_f32 v202, v201, v201
    v_lshlrev_b32 v201, 16, v202
    v_add_f32 v201, v201, v174
    v_cvt_pk_bf16_f32 v202, v201, v201
    v_lshlrev_b32 v201, 16, v202
    v_mul_f32 v204, 0x3fb8aa3b, v201
    v_exp_f32 v204, -v204
    s_nop 0
    v_add_f32 v204, 1.0, v204
    v_rcp_f32 v204, v204
    s_nop 0
    v_mul_f32 v203, v201, v204
    v_cvt_pk_bf16_f32 v202, v203, v203
    v_lshlrev_b32 v203, 16, v202
    v_cvt_pk_bf16_f32 v202, v18, v18
    v_lshlrev_b32 v18, 16, v202
    v_mul_f32 v203, v203, v18
    v_cvt_pk_bf16_f32 v202, v203, v203
    v_lshlrev_b32 v203, 16, v202
    v_add_f32 v18, v200, v203
    v_and_b32 v200, 0xffff0000, v163
    v_sub_f32 v201, v200, v160
    v_cvt_pk_bf16_f32 v202, v201, v201
    v_lshlrev_b32 v201, 16, v202
    v_mul_f32 v201, v201, v170
    v_cvt_pk_bf16_f32 v202, v201, v201
    v_lshlrev_b32 v201, 16, v202
    v_add_f32 v201, v201, v175
    v_cvt_pk_bf16_f32 v202, v201, v201
    v_lshlrev_b32 v201, 16, v202
    v_mul_f32 v204, 0x3fb8aa3b, v201
    v_exp_f32 v204, -v204
    s_nop 0
    v_add_f32 v204, 1.0, v204
    v_rcp_f32 v204, v204
    s_nop 0
    v_mul_f32 v203, v201, v204
    v_cvt_pk_bf16_f32 v202, v203, v203
    v_lshlrev_b32 v203, 16, v202
    v_cvt_pk_bf16_f32 v202, v19, v19
    v_lshlrev_b32 v19, 16, v202
    v_mul_f32 v203, v203, v19
    v_cvt_pk_bf16_f32 v202, v203, v203
    v_lshlrev_b32 v203, 16, v202
    v_add_f32 v19, v200, v203
    v_lshlrev_b32 v200, 16, v164
    v_sub_f32 v201, v200, v160
    v_cvt_pk_bf16_f32 v202, v201, v201
    v_lshlrev_b32 v201, 16, v202
    v_mul_f32 v201, v201, v170
    v_cvt_pk_bf16_f32 v202, v201, v201
    v_lshlrev_b32 v201, 16, v202
    v_add_f32 v201, v201, v176
    v_cvt_pk_bf16_f32 v202, v201, v201
    v_lshlrev_b32 v201, 16, v202
    v_mul_f32 v204, 0x3fb8aa3b, v201
    v_exp_f32 v204, -v204
    s_nop 0
    v_add_f32 v204, 1.0, v204
    v_rcp_f32 v204, v204
    s_nop 0
    v_mul_f32 v203, v201, v204
    v_cvt_pk_bf16_f32 v202, v203, v203
    v_lshlrev_b32 v203, 16, v202
    v_cvt_pk_bf16_f32 v202, v20, v20
    v_lshlrev_b32 v20, 16, v202
    v_mul_f32 v203, v203, v20
    v_cvt_pk_bf16_f32 v202, v203, v203
    v_lshlrev_b32 v203, 16, v202
    v_add_f32 v20, v200, v203
    v_and_b32 v200, 0xffff0000, v164
    v_sub_f32 v201, v200, v160
    v_cvt_pk_bf16_f32 v202, v201, v201
    v_lshlrev_b32 v201, 16, v202
    v_mul_f32 v201, v201, v170
    v_cvt_pk_bf16_f32 v202, v201, v201
    v_lshlrev_b32 v201, 16, v202
    v_add_f32 v201, v201, v177
    v_cvt_pk_bf16_f32 v202, v201, v201
    v_lshlrev_b32 v201, 16, v202
    v_mul_f32 v204, 0x3fb8aa3b, v201
    v_exp_f32 v204, -v204
    s_nop 0
    v_add_f32 v204, 1.0, v204
    v_rcp_f32 v204, v204
    s_nop 0
    v_mul_f32 v203, v201, v204
    v_cvt_pk_bf16_f32 v202, v203, v203
    v_lshlrev_b32 v203, 16, v202
    v_cvt_pk_bf16_f32 v202, v21, v21
    v_lshlrev_b32 v21, 16, v202
    v_mul_f32 v203, v203, v21
    v_cvt_pk_bf16_f32 v202, v203, v203
    v_lshlrev_b32 v203, 16, v202
    v_add_f32 v21, v200, v203
    v_lshlrev_b32 v200, 16, v165
    v_sub_f32 v201, v200, v160
    v_cvt_pk_bf16_f32 v202, v201, v201
    v_lshlrev_b32 v201, 16, v202
    v_mul_f32 v201, v201, v170
    v_cvt_pk_bf16_f32 v202, v201, v201
    v_lshlrev_b32 v201, 16, v202
    v_add_f32 v201, v201, v178
    v_cvt_pk_bf16_f32 v202, v201, v201
    v_lshlrev_b32 v201, 16, v202
    v_mul_f32 v204, 0x3fb8aa3b, v201
    v_exp_f32 v204, -v204
    s_nop 0
    v_add_f32 v204, 1.0, v204
    v_rcp_f32 v204, v204
    s_nop 0
    v_mul_f32 v203, v201, v204
    v_cvt_pk_bf16_f32 v202, v203, v203
    v_lshlrev_b32 v203, 16, v202
    v_cvt_pk_bf16_f32 v202, v22, v22
    v_lshlrev_b32 v22, 16, v202
    v_mul_f32 v203, v203, v22
    v_cvt_pk_bf16_f32 v202, v203, v203
    v_lshlrev_b32 v203, 16, v202
    v_add_f32 v22, v200, v203
    v_and_b32 v200, 0xffff0000, v165
    v_sub_f32 v201, v200, v160
    v_cvt_pk_bf16_f32 v202, v201, v201
    v_lshlrev_b32 v201, 16, v202
    v_mul_f32 v201, v201, v170
    v_cvt_pk_bf16_f32 v202, v201, v201
    v_lshlrev_b32 v201, 16, v202
    v_add_f32 v201, v201, v179
    v_cvt_pk_bf16_f32 v202, v201, v201
    v_lshlrev_b32 v201, 16, v202
    v_mul_f32 v204, 0x3fb8aa3b, v201
    v_exp_f32 v204, -v204
    s_nop 0
    v_add_f32 v204, 1.0, v204
    v_rcp_f32 v204, v204
    s_nop 0
    v_mul_f32 v203, v201, v204
    v_cvt_pk_bf16_f32 v202, v203, v203
    v_lshlrev_b32 v203, 16, v202
    v_cvt_pk_bf16_f32 v202, v23, v23
    v_lshlrev_b32 v23, 16, v202
    v_mul_f32 v203, v203, v23
    v_cvt_pk_bf16_f32 v202, v203, v203
    v_lshlrev_b32 v203, 16, v202
    v_add_f32 v23, v200, v203
    v_lshlrev_b32 v200, 16, v166
    v_sub_f32 v201, v200, v160
    v_cvt_pk_bf16_f32 v202, v201, v201
    v_lshlrev_b32 v201, 16, v202
    v_mul_f32 v201, v201, v170
    v_cvt_pk_bf16_f32 v202, v201, v201
    v_lshlrev_b32 v201, 16, v202
    v_add_f32 v201, v201, v180
    v_cvt_pk_bf16_f32 v202, v201, v201
    v_lshlrev_b32 v201, 16, v202
    v_mul_f32 v204, 0x3fb8aa3b, v201
    v_exp_f32 v204, -v204
    s_nop 0
    v_add_f32 v204, 1.0, v204
    v_rcp_f32 v204, v204
    s_nop 0
    v_mul_f32 v203, v201, v204
    v_cvt_pk_bf16_f32 v202, v203, v203
    v_lshlrev_b32 v203, 16, v202
    v_cvt_pk_bf16_f32 v202, v24, v24
    v_lshlrev_b32 v24, 16, v202
    v_mul_f32 v203, v203, v24
    v_cvt_pk_bf16_f32 v202, v203, v203
    v_lshlrev_b32 v203, 16, v202
    v_add_f32 v24, v200, v203
    v_and_b32 v200, 0xffff0000, v166
    v_sub_f32 v201, v200, v160
    v_cvt_pk_bf16_f32 v202, v201, v201
    v_lshlrev_b32 v201, 16, v202
    v_mul_f32 v201, v201, v170
    v_cvt_pk_bf16_f32 v202, v201, v201
    v_lshlrev_b32 v201, 16, v202
    v_add_f32 v201, v201, v181
    v_cvt_pk_bf16_f32 v202, v201, v201
    v_lshlrev_b32 v201, 16, v202
    v_mul_f32 v204, 0x3fb8aa3b, v201
    v_exp_f32 v204, -v204
    s_nop 0
    v_add_f32 v204, 1.0, v204
    v_rcp_f32 v204, v204
    s_nop 0
    v_mul_f32 v203, v201, v204
    v_cvt_pk_bf16_f32 v202, v203, v203
    v_lshlrev_b32 v203, 16, v202
    v_cvt_pk_bf16_f32 v202, v25, v25
    v_lshlrev_b32 v25, 16, v202
    v_mul_f32 v203, v203, v25
    v_cvt_pk_bf16_f32 v202, v203, v203
    v_lshlrev_b32 v203, 16, v202
    v_add_f32 v25, v200, v203
    v_lshlrev_b32 v200, 16, v167
    v_sub_f32 v201, v200, v160
    v_cvt_pk_bf16_f32 v202, v201, v201
    v_lshlrev_b32 v201, 16, v202
    v_mul_f32 v201, v201, v170
    v_cvt_pk_bf16_f32 v202, v201, v201
    v_lshlrev_b32 v201, 16, v202
    v_add_f32 v201, v201, v182
    v_cvt_pk_bf16_f32 v202, v201, v201
    v_lshlrev_b32 v201, 16, v202
    v_mul_f32 v204, 0x3fb8aa3b, v201
    v_exp_f32 v204, -v204
    s_nop 0
    v_add_f32 v204, 1.0, v204
    v_rcp_f32 v204, v204
    s_nop 0
    v_mul_f32 v203, v201, v204
    v_cvt_pk_bf16_f32 v202, v203, v203
    v_lshlrev_b32 v203, 16, v202
    v_cvt_pk_bf16_f32 v202, v26, v26
    v_lshlrev_b32 v26, 16, v202
    v_mul_f32 v203, v203, v26
    v_cvt_pk_bf16_f32 v202, v203, v203
    v_lshlrev_b32 v203, 16, v202
    v_add_f32 v26, v200, v203
    v_and_b32 v200, 0xffff0000, v167
    v_sub_f32 v201, v200, v160
    v_cvt_pk_bf16_f32 v202, v201, v201
    v_lshlrev_b32 v201, 16, v202
    v_mul_f32 v201, v201, v170
    v_cvt_pk_bf16_f32 v202, v201, v201
    v_lshlrev_b32 v201, 16, v202
    v_add_f32 v201, v201, v183
    v_cvt_pk_bf16_f32 v202, v201, v201
    v_lshlrev_b32 v201, 16, v202
    v_mul_f32 v204, 0x3fb8aa3b, v201
    v_exp_f32 v204, -v204
    s_nop 0
    v_add_f32 v204, 1.0, v204
    v_rcp_f32 v204, v204
    s_nop 0
    v_mul_f32 v203, v201, v204
    v_cvt_pk_bf16_f32 v202, v203, v203
    v_lshlrev_b32 v203, 16, v202
    v_cvt_pk_bf16_f32 v202, v27, v27
    v_lshlrev_b32 v27, 16, v202
    v_mul_f32 v203, v203, v27
    v_cvt_pk_bf16_f32 v202, v203, v203
    v_lshlrev_b32 v203, 16, v202
    v_add_f32 v27, v200, v203
    v_lshlrev_b32 v200, 16, v168
    v_sub_f32 v201, v200, v160
    v_cvt_pk_bf16_f32 v202, v201, v201
    v_lshlrev_b32 v201, 16, v202
    v_mul_f32 v201, v201, v170
    v_cvt_pk_bf16_f32 v202, v201, v201
    v_lshlrev_b32 v201, 16, v202
    v_add_f32 v201, v201, v184
    v_cvt_pk_bf16_f32 v202, v201, v201
    v_lshlrev_b32 v201, 16, v202
    v_mul_f32 v204, 0x3fb8aa3b, v201
    v_exp_f32 v204, -v204
    s_nop 0
    v_add_f32 v204, 1.0, v204
    v_rcp_f32 v204, v204
    s_nop 0
    v_mul_f32 v203, v201, v204
    v_cvt_pk_bf16_f32 v202, v203, v203
    v_lshlrev_b32 v203, 16, v202
    v_cvt_pk_bf16_f32 v202, v28, v28
    v_lshlrev_b32 v28, 16, v202
    v_mul_f32 v203, v203, v28
    v_cvt_pk_bf16_f32 v202, v203, v203
    v_lshlrev_b32 v203, 16, v202
    v_add_f32 v28, v200, v203
    v_and_b32 v200, 0xffff0000, v168
    v_sub_f32 v201, v200, v160
    v_cvt_pk_bf16_f32 v202, v201, v201
    v_lshlrev_b32 v201, 16, v202
    v_mul_f32 v201, v201, v170
    v_cvt_pk_bf16_f32 v202, v201, v201
    v_lshlrev_b32 v201, 16, v202
    v_add_f32 v201, v201, v185
    v_cvt_pk_bf16_f32 v202, v201, v201
    v_lshlrev_b32 v201, 16, v202
    v_mul_f32 v204, 0x3fb8aa3b, v201
    v_exp_f32 v204, -v204
    s_nop 0
    v_add_f32 v204, 1.0, v204
    v_rcp_f32 v204, v204
    s_nop 0
    v_mul_f32 v203, v201, v204
    v_cvt_pk_bf16_f32 v202, v203, v203
    v_lshlrev_b32 v203, 16, v202
    v_cvt_pk_bf16_f32 v202, v29, v29
    v_lshlrev_b32 v29, 16, v202
    v_mul_f32 v203, v203, v29
    v_cvt_pk_bf16_f32 v202, v203, v203
    v_lshlrev_b32 v203, 16, v202
    v_add_f32 v29, v200, v203
    v_lshlrev_b32 v200, 16, v169
    v_sub_f32 v201, v200, v160
    v_cvt_pk_bf16_f32 v202, v201, v201
    v_lshlrev_b32 v201, 16, v202
    v_mul_f32 v201, v201, v170
    v_cvt_pk_bf16_f32 v202, v201, v201
    v_lshlrev_b32 v201, 16, v202
    v_add_f32 v201, v201, v186
    v_cvt_pk_bf16_f32 v202, v201, v201
    v_lshlrev_b32 v201, 16, v202
    v_mul_f32 v204, 0x3fb8aa3b, v201
    v_exp_f32 v204, -v204
    s_nop 0
    v_add_f32 v204, 1.0, v204
    v_rcp_f32 v204, v204
    s_nop 0
    v_mul_f32 v203, v201, v204
    v_cvt_pk_bf16_f32 v202, v203, v203
    v_lshlrev_b32 v203, 16, v202
    v_cvt_pk_bf16_f32 v202, v30, v30
    v_lshlrev_b32 v30, 16, v202
    v_mul_f32 v203, v203, v30
    v_cvt_pk_bf16_f32 v202, v203, v203
    v_lshlrev_b32 v203, 16, v202
    v_add_f32 v30, v200, v203
    v_and_b32 v200, 0xffff0000, v169
    v_sub_f32 v201, v200, v160
    v_cvt_pk_bf16_f32 v202, v201, v201
    v_lshlrev_b32 v201, 16, v202
    v_mul_f32 v201, v201, v170
    v_cvt_pk_bf16_f32 v202, v201, v201
    v_lshlrev_b32 v201, 16, v202
    v_add_f32 v201, v201, v187
    v_cvt_pk_bf16_f32 v202, v201, v201
    v_lshlrev_b32 v201, 16, v202
    v_mul_f32 v204, 0x3fb8aa3b, v201
    v_exp_f32 v204, -v204
    s_nop 0
    v_add_f32 v204, 1.0, v204
    v_rcp_f32 v204, v204
    s_nop 0
    v_mul_f32 v203, v201, v204
    v_cvt_pk_bf16_f32 v202, v203, v203
    v_lshlrev_b32 v203, 16, v202
    v_cvt_pk_bf16_f32 v202, v31, v31
    v_lshlrev_b32 v31, 16, v202
    v_mul_f32 v203, v203, v31
    v_cvt_pk_bf16_f32 v202, v203, v203
    v_lshlrev_b32 v203, 16, v202
    v_add_f32 v31, v200, v203
    v_cvt_pk_bf16_f32 v206, v16, v17
    v_cvt_pk_bf16_f32 v207, v18, v19
    buffer_store_dwordx2 v[206:207], v6, s[44:47], s10 offen offset:0
    v_cvt_pk_bf16_f32 v208, v20, v21
    v_cvt_pk_bf16_f32 v209, v22, v23
    buffer_store_dwordx2 v[208:209], v6, s[44:47], s10 offen offset:16
    v_cvt_pk_bf16_f32 v210, v24, v25
    v_cvt_pk_bf16_f32 v211, v26, v27
    buffer_store_dwordx2 v[210:211], v6, s[44:47], s10 offen offset:32
    v_cvt_pk_bf16_f32 v212, v28, v29
    v_cvt_pk_bf16_f32 v213, v30, v31
    buffer_store_dwordx2 v[212:213], v6, s[44:47], s10 offen offset:48
L_out_end:
    s_endpgm
.section .rodata,"a"
.p2align 6
.amdhsa_kernel out_kernel
  .amdhsa_next_free_vgpr 256
  .amdhsa_next_free_sgpr 102
  .amdhsa_accum_offset 256
  .amdhsa_group_segment_fixed_size 0
  .amdhsa_kernarg_size 88
  .amdhsa_user_sgpr_count 2
  .amdhsa_user_sgpr_kernarg_segment_ptr 1
  .amdhsa_system_sgpr_workgroup_id_x 1
.end_amdhsa_kernel
.text
```
